```python
import torch

def _softmax(x, axis=-1):
    return torch.softmax(x, dim=axis)
def _gelu(x):
    return torch.nn.functional.gelu(x, approximate="tanh")
def _silu(x):
    return torch.nn.functional.silu(x)
def _sigmoid(x):
    return torch.sigmoid(x)
def _layernorm(x, axis=-1, eps=1e-5):
    m = x.mean(dim=axis, keepdim=True)
    v = x.var(dim=axis, keepdim=True, unbiased=False)
    return (x - m) / torch.sqrt(v + eps)
def _scatter_add(tgt, idx, src, axis=0):
    return tgt.clone().index_add_(axis, idx, src)
def _segment_sum(src, seg, n):
    out = torch.zeros((n,) + src.shape[1:], dtype=src.dtype)
    return out.index_add_(0, seg, src)
def _pad(x, pw):
    flat = tuple(v for pair in reversed(pw) for v in pair)
    return torch.nn.functional.pad(x, flat)

kernel_name = 'interleave_layers__sliding_block_cached__mixer_token_mlp__decode'

def setup_inputs():

    _w = (lambda a: (lambda t: t.to(torch.bfloat16) if t.is_floating_point() else t)(torch.as_tensor(a)))
    def _A_setup():
        B, Sq, D = 4, 1, 512
        Hq, Hkv, Sk, Dh = 32, 8, 4096, 128
        assert Hq % Hkv == 0, (Hq, Hkv)
        return {
            "x": _w((lambda *s: torch.randn(*s, dtype=torch.bfloat16) * 0.05)(B, Sq, D)),
            "k_cache": _w((lambda *s: torch.randn(*s, dtype=torch.bfloat16) * 0.8)(B, Hkv, Sk, Dh)),
            "v_cache": _w((lambda *s: torch.randn(*s, dtype=torch.bfloat16) * 1.6)(B, Hkv, Sk, Dh)),
            "wq": _w((lambda *s: torch.randn(*s, dtype=torch.bfloat16) * 0.8)(D, Hq * Dh) * (D ** -0.5)),
            "wo": _w((lambda *s: torch.randn(*s, dtype=torch.bfloat16) * 1.6)(Hq * Dh, D) * ((Hq * Dh) ** -0.5)),
        }
    _A_in = _A_setup()

    def _B_setup():
        B, S, D, F = 4, 1, 512, 1792
        return {
            "x": _w((lambda *s: torch.randn(*s, dtype=torch.bfloat16) * 0.05)(B, S, D)),
            "w1": _w((lambda *s: torch.randn(*s, dtype=torch.bfloat16) * 1.6)(S, F) * (S ** -0.5)),
            "b1": _w((lambda *s: torch.randn(*s, dtype=torch.bfloat16) * 1.6)(F) * 0.02),
            "w2": _w((lambda *s: torch.randn(*s, dtype=torch.bfloat16) * 0.2)(F, S) * (F ** -0.5)),
            "b2": _w((lambda *s: torch.randn(*s, dtype=torch.bfloat16) * 0.2)(S) * 0.02),
        }
    _B_in = _B_setup()

    return {
        "A_x": _A_in["x"],
        "A_k_cache": _A_in["k_cache"],
        "A_v_cache": _A_in["v_cache"],
        "A_wq": _A_in["wq"],
        "A_wo": _A_in["wo"],
        "B_x": _B_in["x"],
        "B_w1": _B_in["w1"],
        "B_b1": _B_in["b1"],
        "B_w2": _B_in["w2"],
        "B_b2": _B_in["b2"],
    }

def reference(A_x, A_k_cache, A_v_cache, A_wq, A_wo, B_x, B_w1, B_b1, B_w2, B_b2):
    def _A_ref(x, k_cache, v_cache, wq, wo):
        B, Sq, D = x.shape
        Hq, Dh = 32, 128
        Hkv, Sk = k_cache.shape[1], k_cache.shape[2]
        W = min(4096, max(256, Sk // 4))
        rep = Hq // Hkv
        q = (lambda x, *d: x.permute(*d))((x @ wq).reshape(B, Sq, Hq, Dh), 0, 2, 1, 3)
        k = (lambda x, n, axis: torch.repeat_interleave(x, n, dim=axis))(k_cache[:, :, Sk - W:, :], rep, axis=1)
        v = (lambda x, n, axis: torch.repeat_interleave(x, n, dim=axis))(v_cache[:, :, Sk - W:, :], rep, axis=1)
        scores = torch.einsum("bhqd,bhkd->bhqk", q, k) * (Dh ** -0.5)
        p = _softmax(scores, axis=-1)
        o = torch.einsum("bhqk,bhkd->bhqd", p, v)
        return (lambda x, *d: x.permute(*d))(o, 0, 2, 1, 3).reshape(B, Sq, Hq * Dh) @ wo

    def _B_ref(x, w1, b1, w2, b2):
        B, S, D = x.shape
        h = _layernorm(x, axis=-1)
        u = torch.einsum("bsd,sf->bdf", h, w1) + b1
        u = _gelu(u)
        y = torch.einsum("bdf,fs->bds", u, w2) + b2
        return (lambda x, *d: x.permute(*d))(y, 0, 2, 1)

    x = A_x
    x = x + _A_ref(_layernorm(x, axis=-1), A_k_cache, A_v_cache, A_wq, A_wo)
    x = x + _B_ref(_layernorm(x, axis=-1), B_w1, B_b1, B_w2, B_b2)
    x = x + _A_ref(_layernorm(x, axis=-1), A_k_cache, A_v_cache, A_wq, A_wo)
    x = x + _B_ref(_layernorm(x, axis=-1), B_w1, B_b1, B_w2, B_b2)
    return x
```

```asm
    ; @launch grid=(256,1,1) block=(512,1,1) lds=163840
.amdgcn_target "amdgcn-amd-amdhsa--gfx950"
.text
.globl interleave_layers__sliding_block_cached__mixer_token_mlp__decode_kernel
.p2align 8
.type interleave_layers__sliding_block_cached__mixer_token_mlp__decode_kernel,@function
interleave_layers__sliding_block_cached__mixer_token_mlp__decode_kernel:
    v_lshrrev_b32 v16, 6, v0
    s_load_dwordx4 s[20:23], s[0:1], 24
    s_load_dwordx4 s[12:15], s[0:1], 8
    v_readfirstlane_b32 s3, v16
    s_load_dwordx8 s[40:47], s[0:1], 48
    s_load_dwordx2 s[8:9], s[0:1], 0
    s_load_dwordx2 s[28:29], s[0:1], 96
    s_cmpk_ge_u32 s2, 256
    s_cbranch_scc1 L_END
    v_and_b32 v1, 63, v0
    s_cmp_lt_u32 s3, 4
    s_cbranch_scc0 L_HELP1
    s_mov_b64 exec, 0
    s_cmp_eq_u32 s3, 1
    s_cbranch_scc1 L_IT1
    s_cmp_eq_u32 s3, 2
    s_cbranch_scc1 L_IT2
    s_cmp_eq_u32 s3, 3
    s_cbranch_scc1 L_IT3
    s_branch L_MAIN1
L_HELP1:
    s_getpc_b64 s[76:77]
L_PC:
    s_and_b32 s71, s3, 3
    s_lshr_b32 s68, s2, 3
    s_lshl_b32 s68, s68, 2
    s_add_u32 s68, s68, s71
    s_lshl_b32 s68, s68, 7
    v_min_u32 v17, 1, v1
    v_lshl_add_u32 v17, v17, 6, s68
    global_load_dword v62, v17, s[76:77]
    v_lshlrev_b32 v28, 4, v1
    s_lshl_b32 s71, s71, 10
    s_add_u32 m0, s71, 136192
    v_add_u32 v24, s71, v28
    v_min_u32 v25, 3568, v24
    s_waitcnt lgkmcnt(0)
    global_load_lds_dwordx4 v25, s[40:41]
    s_add_u32 m0, m0, 4096
    s_load_dword s60, s[28:29], 0
    global_load_lds_dwordx4 v25, s[42:43]
    s_add_u32 m0, m0, 4096
    s_load_dword s54, s[46:47], 0
    global_load_lds_dwordx4 v25, s[44:45]
    s_add_u32 m0, m0, 4096
    s_setprio 3
    global_load_lds_dwordx4 v24, s[8:9]
    s_branch L_HELP2
.p2align 8
L_MAIN1:
    s_mov_b64 exec, -1
    s_setprio 2
    v_mov_b32 v21, 0
    v_mov_b32 v40, 128512
    v_lshl_add_u32 v20, v1, 2, v40
    ds_write_b32 v20, v21
    v_and_b32 v18, 15, v1
    v_lshrrev_b32 v19, 4, v1
    s_and_b32 s4, s2, 7
    s_bfe_u32 s5, s2, 0x30003
    s_lshr_b32 s6, s2, 6
    v_and_b32 v23, 7, v1
    v_and_b32 v22, 1, v19
    v_lshlrev_b32 v22, 1, v22
    v_xor_b32 v23, v23, v22
    v_lshlrev_b32 v23, 4, v23
    v_lshrrev_b32 v24, 3, v1
    v_lshl_add_u32 v54, v24, 13, v23
    v_xor_b32 v55, 64, v54
    s_lshl_b32 s68, s4, 3
    s_add_u32 s68, s68, s5
    s_lshl_b32 s79, s68, 7
    s_lshl_b32 s69, s6, 2
    s_add_u32 s69, s69, s3
    s_lshl_b32 s69, s69, 18
    s_add_u32 s69, s69, s79
    s_lshl_b32 s70, s3, 12
    s_add_u32 s70, s70, 103424
    s_lshl_b32 s7, s6, 3
    s_add_u32 s7, s7, s4
    s_lshl_b32 s59, s7, 5
    s_add_u32 s59, s59, s5
    s_add_u32 s59, s59, 24
    s_lshl_b32 s59, s59, 2
    s_add_u32 s59, s59, s3
    s_lshl_b32 s59, s59, 13
    v_xor_b32 v25, v18, v19
    v_lshlrev_b32 v26, 8, v19
L_IT1:
    s_cbranch_execz L_MAIN1
    v_lshl_add_u32 v26, v25, 4, v26
    v_xor_b32 v27, 64, v26
    s_waitcnt lgkmcnt(0)
    s_mov_b64 s[24:25], s[22:23]
    s_mov_b32 s22, 0x400000
    s_mov_b32 s23, 0x20000
    s_mov_b64 s[16:17], s[14:15]
    s_mov_b32 s14, 33554432
    s_mov_b32 s15, 0x20000
    s_mov_b32 m0, s70
    s_nop 0
    buffer_load_dwordx4 v54, s[20:23], s69 offen offset:0 lds
    s_add_u32 s69, s69, 64512
    buffer_load_dwordx4 v55, s[20:23], s69 offen offset:1024 lds
    s_add_u32 s69, s69, 64512
    buffer_load_dwordx4 v54, s[20:23], s69 offen offset:2048 lds
    s_add_u32 s69, s69, 64512
    buffer_load_dwordx4 v55, s[20:23], s69 offen offset:3072 lds
    s_lshl_b32 s78, s3, 13
    s_mov_b32 m0, s78
L_IT2:
    s_cbranch_execz L_MAIN1
    s_add_u32 s88, s59, 4096
    v_xor_b32 v28, 0x80, v26
    v_xor_b32 v29, 0xc0, v26
    v_lshlrev_b32 v30, 1, v19
    v_xor_b32 v30, v18, v30
    v_lshlrev_b32 v30, 4, v30
    v_lshl_add_u32 v30, v19, 8, v30
    v_xor_b32 v31, 0x80, v30
    s_barrier
    s_mov_b32 m0, s78
    s_nop 0
    buffer_load_dwordx4 v26, s[12:15], s59 offen offset:0 nt lds
    buffer_load_dwordx4 v26, s[12:15], s59 offen offset:1024 nt lds
    buffer_load_dwordx4 v27, s[12:15], s59 offen offset:2048 nt lds
    buffer_load_dwordx4 v27, s[12:15], s59 offen offset:3072 nt lds
L_IT3:
    s_cbranch_execz L_MAIN1
    s_mul_i32 s34, s3, 3
    s_lshl_b32 s35, s6, 2
    s_add_u32 s34, s34, s35
    s_load_dwordx2 s[36:37], s[0:1], 80
    s_cmp_lg_u32 s3, 2
    s_cbranch_scc1 L_NE
    s_load_dword s53, s[28:29], 0
L_NE:
    s_mov_b32 s18, 33554432
    s_mov_b32 s19, 0x20000
    s_mov_b32 s26, 4194304
    s_mov_b32 s27, 0x20000
    s_mov_b32 s30, 268435456
    s_mov_b32 s31, 0x20000
    s_mov_b32 s38, 4096
    s_mov_b32 s39, 0x20000
    v_lshlrev_b32 v2, 2, v1
    s_mov_b32 s58, 0x200000
    s_mov_b32 s57, 0
    v_mov_b32_e64 v41, 1
    s_mov_b32 s60, 983055
    s_mov_b32 s61, 983055
    s_mov_b32 s62, 15728880
    s_mov_b32 s63, 15728880
    s_mov_b32 s64, 251662080
    s_mov_b32 s65, 251662080
    s_mov_b32 s66, 4026593280
    s_mov_b32 s67, 4026593280
    v_and_b32 v20, 3, v18
    v_lshrrev_b32 v21, 2, v18
    v_lshl_add_u32 v22, v19, 3, v21
    v_lshlrev_b32 v37, 8, v22
    v_lshlrev_b32 v22, 7, v22
    v_lshrrev_b32 v25, 3, v18
    v_and_b32 v32, 1, v19
    v_lshl_or_b32 v25, v32, 1, v25
    v_bfe_u32 v33, v18, 1, 1
    v_lshl_or_b32 v25, v25, 1, v33
    v_lshl_add_u32 v22, v25, 4, v22
    v_and_b32_e64 v34, 1, v18
    v_lshl_add_u32 v13, v34, 3, v22
    v_lshl_add_u32 v22, v32, 2, v21
    v_lshl_or_b32 v22, v22, 1, v33
    v_lshl_add_u32 v37, v22, 4, v37
    v_lshl_add_u32 v37, v34, 3, v37
    s_lshl_b32 s68, s3, 13
    s_add_u32 s69, s68, 32768
    v_add_u32 v37, s69, v37
    v_xor_b32 v25, v18, v19
    v_lshlrev_b32 v33, 11, v21
    v_lshl_add_u32 v33, v20, 8, v33
    v_lshl_add_u32 v33, v25, 4, v33
    v_add_u32 v33, s68, v33
    v_xor_b32 v34, 64, v33
    v_xor_b32 v35, 0x80, v33
    v_xor_b32 v36, 0xc0, v33
    v_lshlrev_b32_e64 v3, 6, v19
    v_lshl_add_u32 v3, v20, 4, v3
    v_mul_u32_u24 v32, 272, v20
    v_lshl_add_u32 v32, v19, 4, v32
    v_add_u32 v32, 128768, v32
    v_lshlrev_b32 v22, 4, v18
    v_lshl_add_u32 v4, v19, 7, v22
    v_lshl_add_u32 v22, v19, 2, v18
    v_and_b32 v22, 7, v22
    v_lshlrev_b32 v5, 3, v22
    v_lshrrev_b32 v22, 2, v1
    s_lshl_b32 s68, s6, 2
    v_subrev_u32 v22, s68, v22
    v_and_b32 v22, 15, v22
    v_lshlrev_b32 v25, 2, v20
    v_lshl_add_u32 v15, v22, 7, v25
    s_mul_i32 s68, s3, 2112
    s_add_u32 s68, s68, 119808
    v_mul_u32_u24 v22, 528, v20
    v_lshl_add_u32 v22, v21, 6, v22
    v_lshl_add_u32 v22, v19, 4, v22
    v_add_u32_e64 v6, s68, v22
    s_mul_i32 s68, s3, 528
    s_add_u32 s68, s68, 119808
    v_lshl_add_u32 v7, v1, 3, s68
    v_bfe_u32 v22, v1, 1, 1
    v_lshlrev_b32 v22, 10, v22
    v_lshl_add_u32 v22, v21, 8, v22
    v_lshl_add_u32 v22, v19, 4, v22
    v_and_b32 v25, 1, v1
    v_lshl_add_u32 v22, v25, 3, v22
    s_lshl_b32 s68, s3, 6
    s_add_u32 s68, s68, 152576
    v_add_u32 v8, s68, v22
    s_lshl_b32 s68, s6, 2
    v_add_u32 v22, s68, v18
    v_and_b32 v22, 15, v22
    v_lshl_add_u32 v22, v19, 4, v22
    v_lshlrev_b32 v22, 4, v22
    v_add_u32 v9, 152576, v22
    s_mul_i32 s80, s7, 9216
    s_add_u32 s80, s80, 561152
    s_lshl_b32 s68, s3, 6
    s_add_u32 s82, s80, s68
    s_add_u32 s82, s82, 8192
    s_lshl_b32 s68, s3, 11
    s_add_u32 s80, s80, s68
    s_lshl_b32 s68, s5, 4
    s_add_u32 s81, s80, s68
    s_lshl_b32 s68, s3, 8
    s_lshl_b32 s83, s6, 13
    s_add_u32 s83, s83, 1150976
    s_add_u32 s85, s83, s79
    s_add_u32 s83, s83, s68
    s_add_u32 s84, s83, 4096
    s_lshl_b32 s86, s7, 10
    s_add_u32 s86, s86, 528384
    s_and_b32 s68, s5, 1
    s_lshl_b32 s68, s68, 9
    s_add_u32 s87, s86, s68
    s_lshr_b32 s68, s5, 1
    s_lshl_b32 s68, s68, 4
    s_add_u32 s87, s87, s68
    s_lshl_b32 s68, s3, 7
    s_add_u32 s87, s87, s68
    s_mov_b32 s33, 65536
    s_cmp_eq_u32 s3, 1
    s_cselect_b32 s33, 131072, s33
    s_cmp_eq_u32 s3, 2
    s_cselect_b32 s33, 152576, s33
    s_cmp_eq_u32 s3, 3
    s_cselect_b32 s33, 156928, s33
    s_mov_b32 s94, 0x00ff00ff
    s_mov_b32 s95, 0x00ff00ff
    s_lshl_b32 s68, s4, 19
    s_lshl_b32 s69, s3, 17
    s_add_u32 s68, s68, s69
    s_lshl_b32 s69, s5, 7
    s_add_u32 s68, s68, s69
    v_lshl_add_u32 v38, v24, 10, v23
    v_add_u32 v38, s68, v38
    v_xor_b32 v39, 64, v38
    s_lshl_b32 s68, s6, 10
    s_lshl_b32 s69, s3, 8
    s_add_u32 s68, s68, s69
    s_add_u32 s68, s68, 148480
    v_add_u32 v0, s68, v2
    s_cmp_lg_u32 s3, 0
    s_cbranch_scc1 L_STREAM
    v_lshlrev_b32 v48, 4, v19
    v_lshl_add_u32 v48, v21, 8, v48
    v_lshl_add_u32 v48, v20, 10, v48
    v_add_u32 v48, 148480, v48
L_sp1:
    ds_read_b32 v42, v40 offset:28
    s_waitcnt lgkmcnt(0)
    v_readfirstlane_b32 s72, v42
    s_nop 0
    s_cmp_ge_u32 s72, 4
    s_cbranch_scc1 L_spd2
    s_nop 0
    s_sleep 1
    s_sub_u32 s58, s58, 1
    s_cbranch_scc0 L_sp1
    s_mov_b32 s58, 0
L_spd2:
    ds_read_b128 v[128:131], v48 offset:0
    ds_read_b128 v[132:135], v48 offset:64
    ds_read_b128 v[136:139], v48 offset:128
    ds_read_b128 v[140:143], v48 offset:192
    v_add_u32 v44, 103424, v13
    v_xor_b32 v45, 32, v44
    v_xor_b32 v46, 64, v44
    v_xor_b32 v47, 0x60, v44
    v_lshlrev_b32 v48, 8, v20
    v_lshl_add_u32 v48, v19, 4, v48
    v_add_u32 v48, 129792, v48
    v_lshlrev_b32 v51, 4, v1
    v_add_u32 v49, 129792, v51
    v_lshlrev_b32 v50, 16, v19
    v_lshl_add_u32 v50, v18, 4, v50
    s_lshl_b32 s68, s4, 13
    s_lshl_b32 s69, s5, 8
    s_add_u32 s68, s68, s69
    s_lshl_b32 s69, s6, 11
    s_add_u32 s68, s68, s69
    s_add_u32 s68, s68, 4096
    s_add_u32 s71, s68, 262144
    s_lshl_b32 s69, s6, 2
    s_lshl_b32 s70, s60, s69
    s_waitcnt lgkmcnt(0)
    v_mov_b32 v42, 0
    v_mov_b32 v43, 0
    s_mov_b32 s72, 0x3f803f80
    v_dot2c_f32_bf16 v42, s72, v128
    v_dot2c_f32_bf16 v43, v128, v128
    v_dot2c_f32_bf16 v42, s72, v129
    v_dot2c_f32_bf16 v43, v129, v129
    v_dot2c_f32_bf16 v42, s72, v130
    v_dot2c_f32_bf16 v43, v130, v130
    v_dot2c_f32_bf16 v42, s72, v131
    v_dot2c_f32_bf16 v43, v131, v131
    v_dot2c_f32_bf16 v42, s72, v132
    v_dot2c_f32_bf16 v43, v132, v132
    v_dot2c_f32_bf16 v42, s72, v133
    v_dot2c_f32_bf16 v43, v133, v133
    v_dot2c_f32_bf16 v42, s72, v134
    v_dot2c_f32_bf16 v43, v134, v134
    v_dot2c_f32_bf16 v42, s72, v135
    v_dot2c_f32_bf16 v43, v135, v135
    v_dot2c_f32_bf16 v42, s72, v136
    v_dot2c_f32_bf16 v43, v136, v136
    v_dot2c_f32_bf16 v42, s72, v137
    v_dot2c_f32_bf16 v43, v137, v137
    v_dot2c_f32_bf16 v42, s72, v138
    v_dot2c_f32_bf16 v43, v138, v138
    v_dot2c_f32_bf16 v42, s72, v139
    v_dot2c_f32_bf16 v43, v139, v139
    v_dot2c_f32_bf16 v42, s72, v140
    v_dot2c_f32_bf16 v43, v140, v140
    v_dot2c_f32_bf16 v42, s72, v141
    v_dot2c_f32_bf16 v43, v141, v141
    v_dot2c_f32_bf16 v42, s72, v142
    v_dot2c_f32_bf16 v43, v142, v142
    v_dot2c_f32_bf16 v42, s72, v143
    v_dot2c_f32_bf16 v43, v143, v143
    v_lshlrev_b32 v144, 16, v128
    v_and_b32 v145, 0xffff0000, v128
    v_lshlrev_b32_e64 v146, 16, v129
    v_and_b32 v147, 0xffff0000, v129
    v_add_f32_dpp v42, v42, v42 row_ror:4 row_mask:0xf bank_mask:0xf
    v_add_f32_dpp v43, v43, v43 row_ror:4 row_mask:0xf bank_mask:0xf
    s_nop 0
    v_add_f32_dpp v42, v42, v42 row_ror:8 row_mask:0xf bank_mask:0xf
    v_add_f32_dpp v43, v43, v43 row_ror:8 row_mask:0xf bank_mask:0xf
    v_mov_b32 v52, v42
    v_mov_b32 v53, v43
    s_nop 0
    v_permlane16_swap_b32 v42, v52
    v_permlane16_swap_b32 v43, v53
    v_add_f32 v42, v42, v52
    v_add_f32 v43, v43, v53
    v_mov_b32 v52, v42
    v_mov_b32 v53, v43
    s_nop 0
    v_permlane32_swap_b32 v42, v52
    v_permlane32_swap_b32 v43, v53
    v_add_f32 v42, v42, v52
    v_add_f32_e64 v43, v43, v53
    v_mul_f32 v42, 989855744, v42
    v_mul_f32 v43, 989855744, v43
    v_fma_f32 v43, -v42, v42, v43
    v_max_f32 v43, 0, v43
    v_add_f32 v43, 925353388, v43
    v_rsq_f32 v43, v43
    v_lshlrev_b32 v148, 16, v130
    v_and_b32 v149, 0xffff0000, v130
    v_lshlrev_b32 v150, 16, v131
    v_and_b32 v151, 0xffff0000, v131
    v_lshlrev_b32 v152, 16, v132
    v_and_b32 v153, 0xffff0000, v132
    v_lshlrev_b32 v154, 16, v133
    v_and_b32 v155, 0xffff0000, v133
    v_lshlrev_b32 v156, 16, v134
    v_and_b32 v157, 0xffff0000, v134
    v_lshlrev_b32 v158, 16, v135
    v_and_b32 v159, 0xffff0000, v135
    v_lshlrev_b32 v160, 16, v136
    v_and_b32 v161, 0xffff0000, v136
    v_lshlrev_b32 v162, 16, v137
    v_and_b32 v163, 0xffff0000, v137
    v_lshlrev_b32 v164, 16, v138
    v_and_b32 v165, 0xffff0000, v138
    v_lshlrev_b32 v166, 16, v139
    v_and_b32 v167, 0xffff0000, v139
    v_lshlrev_b32 v168, 16, v140
    v_and_b32 v169, 0xffff0000, v140
    v_lshlrev_b32 v170, 16, v141
    v_and_b32 v171, 0xffff0000, v141
    v_lshlrev_b32 v172, 16, v142
    v_and_b32 v173, 0xffff0000, v142
    v_lshlrev_b32 v174, 16, v143
    v_and_b32 v175, 0xffff0000, v143
    v_mul_f32 v52, 1040356334, v43
    v_mul_f32_e64 v42, v42, v52
    v_pk_fma_f32 v[144:145], v[144:145], v[52:53], v[42:43] op_sel_hi:[1,0,0] neg_lo:[0,0,1] neg_hi:[0,0,1]
    v_pk_fma_f32 v[146:147], v[146:147], v[52:53], v[42:43] op_sel_hi:[1,0,0] neg_lo:[0,0,1] neg_hi:[0,0,1]
    v_pk_fma_f32 v[148:149], v[148:149], v[52:53], v[42:43] op_sel_hi:[1,0,0] neg_lo:[0,0,1] neg_hi:[0,0,1]
    v_pk_fma_f32 v[150:151], v[150:151], v[52:53], v[42:43] op_sel_hi:[1,0,0] neg_lo:[0,0,1] neg_hi:[0,0,1]
    v_pk_fma_f32 v[152:153], v[152:153], v[52:53], v[42:43] op_sel_hi:[1,0,0] neg_lo:[0,0,1] neg_hi:[0,0,1]
    v_pk_fma_f32 v[154:155], v[154:155], v[52:53], v[42:43] op_sel_hi:[1,0,0] neg_lo:[0,0,1] neg_hi:[0,0,1]
    v_pk_fma_f32 v[156:157], v[156:157], v[52:53], v[42:43] op_sel_hi:[1,0,0] neg_lo:[0,0,1] neg_hi:[0,0,1]
    v_pk_fma_f32 v[158:159], v[158:159], v[52:53], v[42:43] op_sel_hi:[1,0,0] neg_lo:[0,0,1] neg_hi:[0,0,1]
    v_pk_fma_f32 v[160:161], v[160:161], v[52:53], v[42:43] op_sel_hi:[1,0,0] neg_lo:[0,0,1] neg_hi:[0,0,1]
    v_pk_fma_f32 v[162:163], v[162:163], v[52:53], v[42:43] op_sel_hi:[1,0,0] neg_lo:[0,0,1] neg_hi:[0,0,1]
    v_pk_fma_f32 v[164:165], v[164:165], v[52:53], v[42:43] op_sel_hi:[1,0,0] neg_lo:[0,0,1] neg_hi:[0,0,1]
    v_pk_fma_f32 v[166:167], v[166:167], v[52:53], v[42:43] op_sel_hi:[1,0,0] neg_lo:[0,0,1] neg_hi:[0,0,1]
    v_pk_fma_f32 v[168:169], v[168:169], v[52:53], v[42:43] op_sel_hi:[1,0,0] neg_lo:[0,0,1] neg_hi:[0,0,1]
    v_pk_fma_f32 v[170:171], v[170:171], v[52:53], v[42:43] op_sel_hi:[1,0,0] neg_lo:[0,0,1] neg_hi:[0,0,1]
    v_pk_fma_f32 v[172:173], v[172:173], v[52:53], v[42:43] op_sel_hi:[1,0,0] neg_lo:[0,0,1] neg_hi:[0,0,1]
    v_pk_fma_f32 v[174:175], v[174:175], v[52:53], v[42:43] op_sel_hi:[1,0,0] neg_lo:[0,0,1] neg_hi:[0,0,1]
    v_cvt_pk_bf16_f32 v128, v144, v145
    v_cvt_pk_bf16_f32 v129, v146, v147
    v_cvt_pk_bf16_f32 v130, v148, v149
    v_cvt_pk_bf16_f32 v131, v150, v151
    v_cvt_pk_bf16_f32 v132, v152, v153
    v_cvt_pk_bf16_f32 v133, v154, v155
    v_cvt_pk_bf16_f32 v134, v156, v157
    v_cvt_pk_bf16_f32 v135, v158, v159
    v_cvt_pk_bf16_f32 v136, v160, v161
    v_cvt_pk_bf16_f32 v137, v162, v163
    v_cvt_pk_bf16_f32 v138, v164, v165
    v_cvt_pk_bf16_f32 v139, v166, v167
    v_cvt_pk_bf16_f32 v140, v168, v169
    v_cvt_pk_bf16_f32 v141, v170, v171
    v_cvt_pk_bf16_f32 v142, v172, v173
    v_cvt_pk_bf16_f32 v143, v174, v175
    s_waitcnt vmcnt(4)
    s_mov_b64 exec, 1
    ds_add_u32 v40, v41 offset:16
    s_mov_b64 exec, -1
    s_add_u32 m0, s78, 4096
    s_nop 0
    buffer_load_dwordx4 v28, s[12:15], s88 offen offset:0 nt lds
    buffer_load_dwordx4 v28, s[12:15], s88 offen offset:1024 nt lds
    buffer_load_dwordx4 v29, s[12:15], s88 offen offset:2048 nt lds
    buffer_load_dwordx4 v29, s[12:15], s88 offen offset:3072 nt lds
L_sp3:
    ds_read_b32 v42, v40 offset:0
    s_waitcnt lgkmcnt(0)
    v_readfirstlane_b32 s55, v42
    s_nop 0
    s_cmp_ge_u32 s55, 1
    s_cbranch_scc1 L_spd4
    s_sub_u32 s58, s58, 1
    s_cbranch_scc0 L_sp3
    s_mov_b32 s58, 0
L_spd4:
    v_mov_b32 v145, s55
    v_mov_b32 v147, s55
    v_mov_b32 v149, s55
    v_mov_b32 v151, s55
    v_mov_b32 v153, s55
    v_mov_b32 v155, s55
    v_mov_b32 v157, s55
    v_mov_b32 v159, s55
L_sp5:
    ds_read_b32 v42, v40 offset:16
    s_waitcnt lgkmcnt(0)
    v_readfirstlane_b32 s72, v42
    s_nop 0
    s_cmp_ge_u32 s72, 4
    s_cbranch_scc1 L_spd6
    s_nop 0
    s_sleep 1
    s_sub_u32 s58, s58, 1
    s_cbranch_scc0 L_sp5
    s_mov_b32 s58, 0
L_spd6:
    ds_read_b64_tr_b16 v[192:193], v44 offset:0
    ds_read_b64_tr_b16 v[194:195], v44 offset:512
    ds_read_b64_tr_b16 v[196:197], v45 offset:0
    ds_read_b64_tr_b16 v[198:199], v45 offset:512
    ds_read_b64_tr_b16 v[200:201], v46 offset:0
    ds_read_b64_tr_b16 v[202:203], v46 offset:512
    ds_read_b64_tr_b16 v[204:205], v47 offset:0
    ds_read_b64_tr_b16 v[206:207], v47 offset:512
    ds_read_b64_tr_b16 v[208:209], v44 offset:4096
    ds_read_b64_tr_b16 v[210:211], v44 offset:4608
    ds_read_b64_tr_b16 v[212:213], v45 offset:4096
    ds_read_b64_tr_b16 v[214:215], v45 offset:4608
    ds_read_b64_tr_b16 v[216:217], v46 offset:4096
    ds_read_b64_tr_b16 v[218:219], v46 offset:4608
    ds_read_b64_tr_b16 v[220:221], v47 offset:4096
    ds_read_b64_tr_b16 v[222:223], v47 offset:4608
    ds_read_b64_tr_b16 v[224:225], v44 offset:8192
    ds_read_b64_tr_b16 v[226:227], v44 offset:8704
    ds_read_b64_tr_b16 v[228:229], v45 offset:8192
    ds_read_b64_tr_b16 v[230:231], v45 offset:8704
    ds_read_b64_tr_b16 v[232:233], v46 offset:8192
    ds_read_b64_tr_b16 v[234:235], v46 offset:8704
    ds_read_b64_tr_b16 v[236:237], v47 offset:8192
    ds_read_b64_tr_b16 v[238:239], v47 offset:8704
    ds_read_b64_tr_b16 v[240:241], v44 offset:12288
    ds_read_b64_tr_b16 v[242:243], v44 offset:12800
    ds_read_b64_tr_b16 v[244:245], v45 offset:12288
    ds_read_b64_tr_b16 v[246:247], v45 offset:12800
    ds_read_b64_tr_b16 v[248:249], v46 offset:12288
    ds_read_b64_tr_b16 v[250:251], v46 offset:12800
    ds_read_b64_tr_b16 v[252:253], v47 offset:12288
    ds_read_b64_tr_b16 v[254:255], v47 offset:12800
    s_waitcnt lgkmcnt(15)
    v_mfma_f32_16x16x32_bf16 v[176:179], v[192:195], v[128:131], 0
    v_mfma_f32_16x16x32_bf16 v[180:183], v[196:199], v[128:131], 0
    v_mfma_f32_16x16x32_bf16 v[184:187], v[200:203], v[128:131], 0
    v_mfma_f32_16x16x32_bf16 v[188:191], v[204:207], v[128:131], 0
    s_waitcnt lgkmcnt(15)
    v_mfma_f32_16x16x32_bf16 v[176:179], v[208:211], v[132:135], v[176:179]
    v_mfma_f32_16x16x32_bf16 v[180:183], v[212:215], v[132:135], v[180:183]
    v_mfma_f32_16x16x32_bf16 v[184:187], v[216:219], v[132:135], v[184:187]
    v_mfma_f32_16x16x32_bf16 v[188:191], v[220:223], v[132:135], v[188:191]
    s_waitcnt lgkmcnt(8)
    v_mfma_f32_16x16x32_bf16 v[176:179], v[224:227], v[136:139], v[176:179]
    v_mfma_f32_16x16x32_bf16 v[180:183], v[228:231], v[136:139], v[180:183]
    v_mfma_f32_16x16x32_bf16 v[184:187], v[232:235], v[136:139], v[184:187]
    v_mfma_f32_16x16x32_bf16 v[188:191], v[236:239], v[136:139], v[188:191]
    s_waitcnt lgkmcnt(0)
    v_mfma_f32_16x16x32_bf16 v[176:179], v[240:243], v[140:143], v[176:179]
    v_mfma_f32_16x16x32_bf16 v[180:183], v[244:247], v[140:143], v[180:183]
    v_mfma_f32_16x16x32_bf16 v[184:187], v[248:251], v[140:143], v[184:187]
    v_mfma_f32_16x16x32_bf16 v[188:191], v[252:255], v[140:143], v[188:191]
    s_nop 4
    v_cvt_pk_bf16_f32 v144, v176, v177
    v_cvt_pk_bf16_f32 v146, v178, v179
    v_cvt_pk_bf16_f32 v148, v180, v181
    v_cvt_pk_bf16_f32 v150, v182, v183
    v_cvt_pk_bf16_f32 v152, v184, v185
    v_cvt_pk_bf16_f32 v154, v186, v187
    v_cvt_pk_bf16_f32 v156, v188, v189
    v_cvt_pk_bf16_f32 v158, v190, v191
    s_mov_b32 exec_lo, s70
    s_mov_b32 exec_hi, s70
    ds_write_b128 v48, v[144:147] offset:0
    ds_write_b128 v48, v[148:151] offset:64
    ds_write_b128 v48, v[152:155] offset:128
    ds_write_b128 v48, v[156:159] offset:192
    s_mov_b64 exec, -1
    ds_read_b128 v[128:131], v49
    s_waitcnt lgkmcnt(0)
    buffer_store_dwordx4 v[128:131], v50, s[28:31], s68 offen
    buffer_store_dwordx4 v[128:131], v50, s[28:31], s71 offen sc1
    s_lshl_b32 s72, s7, 13
    s_add_u32 s72, s72, 4096
    s_add_u32 s73, s72, 0
    s_add_u32 s74, s73, 4096
    s_mov_b32 s75, 0
    v_lshrrev_b32 v48, 5, v1
    v_lshlrev_b32 v48, 4, v48
    v_lshl_add_u32 v48, v1, 3, v48
    v_add_u32 v48, 128768, v48
    s_waitcnt vmcnt(5)
    s_add_u32 m0, s78, 32768
    s_nop 0
    buffer_load_dwordx4 v30, s[16:19], s59 offen offset:0 nt lds
    s_waitcnt vmcnt(5)
    s_add_u32 m0, s78, 32768
    s_nop 0
    buffer_load_dwordx4 v30, s[16:19], s59 offen offset:1024 nt lds
    s_waitcnt vmcnt(5)
    s_add_u32 m0, s78, 32768
    s_nop 0
    buffer_load_dwordx4 v31, s[16:19], s59 offen offset:2048 nt lds
    s_waitcnt vmcnt(5)
    s_add_u32 m0, s78, 32768
    s_nop 0
    buffer_load_dwordx4 v31, s[16:19], s59 offen offset:3072 nt lds
    s_nop 0
    s_waitcnt vmcnt(6)
    ds_read_b128 v[64:67], v33 offset:0
    ds_read_b128 v[68:71], v34 offset:0
    ds_read_b128 v[72:75], v35 offset:0
    ds_read_b128 v[76:79], v36 offset:0
    ds_read_b128 v[80:83], v33 offset:1024
    ds_read_b128 v[84:87], v34 offset:1024
    ds_read_b128 v[88:91], v35 offset:1024
    ds_read_b128 v[92:95], v36 offset:1024
    s_waitcnt lgkmcnt(0)
    s_nop 0
    s_waitcnt vmcnt(3)
    s_add_u32 m0, s78, 36864
    s_nop 0
    buffer_load_dwordx4 v30, s[16:19], s88 offen offset:0 nt lds
    s_mov_b64 exec, 1
    ds_add_u32 v40, v41 offset:36
    s_mov_b64 exec, -1
    buffer_load_dwordx4 v[192:195], v51, s[28:31], s73 offen offset:0 sc1
    buffer_load_dwordx4 v[196:199], v51, s[28:31], s73 offen offset:1024 sc1
    buffer_load_dwordx4 v[200:203], v51, s[28:31], s73 offen offset:2048 sc1
    buffer_load_dwordx4 v[204:207], v51, s[28:31], s73 offen offset:3072 sc1
    buffer_load_dwordx4 v[208:211], v51, s[28:31], s74 offen offset:0 sc1
    buffer_load_dwordx4 v[212:215], v51, s[28:31], s74 offen offset:1024 sc1
    buffer_load_dwordx4 v[216:219], v51, s[28:31], s74 offen offset:2048 sc1
    buffer_load_dwordx4 v[220:223], v51, s[28:31], s74 offen offset:3072 sc1
    s_add_u32 m0, s78, 36864
    s_nop 0
    buffer_load_dwordx4 v30, s[16:19], s88 offen offset:1024 nt lds
    s_add_u32 m0, s78, 36864
    s_nop 0
    buffer_load_dwordx4 v31, s[16:19], s88 offen offset:2048 nt lds
    s_add_u32 m0, s78, 36864
    s_nop 0
    buffer_load_dwordx4 v31, s[16:19], s88 offen offset:3072 nt lds
    s_add_u32 s35, s6, 0
    s_and_b32 s35, s35, 3
    s_lshl_b32 s35, s35, 15
    s_add_u32 m0, s78, 70656
    s_nop 0
    buffer_load_dwordx4 v38, s[24:27], s35 offen offset:0 lds
    s_add_u32 s35, s35, 7168
    s_add_u32 m0, s78, 70656
    s_nop 0
    buffer_load_dwordx4 v39, s[24:27], s35 offen offset:1024 lds
    s_add_u32 s35, s35, 7168
    s_add_u32 m0, s78, 70656
    s_nop 0
    buffer_load_dwordx4 v38, s[24:27], s35 offen offset:2048 lds
    s_add_u32 s35, s35, 7168
    s_add_u32 m0, s78, 70656
    s_nop 0
    buffer_load_dwordx4 v39, s[24:27], s35 offen offset:3072 lds
    s_setprio 3
    s_waitcnt vmcnt(7)
L_G1C:
    v_max3_u32 v42, v193, v195, v197
    v_min3_u32 v43, v193, v195, v197
    v_max3_u32 v42, v42, v199, v201
    v_min3_u32 v43, v43, v199, v201
    v_max3_u32 v42, v42, v203, v205
    v_min3_u32 v43, v43, v203, v205
    v_max3_u32 v42, v42, v207, v209
    v_min3_u32 v43, v43, v207, v209
    v_max3_u32 v42, v42, v211, v213
    v_min3_u32 v43, v43, v211, v213
    v_max3_u32 v42, v42, v215, v217
    v_min3_u32 v43, v43, v215, v217
    v_max3_u32 v42, v42, v219, v221
    v_min3_u32 v43, v43, v219, v221
    v_max_u32 v42, v42, v223
    v_min_u32 v43, v43, v223
    v_xor_b32 v42, s55, v42
    v_xor_b32 v43, s55, v43
    v_or_b32 v42, v42, v43
    v_cmp_ne_u32 vcc, 0, v42
    s_cbranch_vccz L_G1OK
    s_sub_u32 s58, s58, 1
    s_cbranch_scc1 L_G1TO
    s_mov_b64 exec, vcc
    s_add_u32 s75, s75, 1
    s_and_b32 s73, s75, 3
    s_cmp_eq_u32 s73, 3
    s_cselect_b32 s73, 262144, 0
    s_add_u32 s73, s73, s72
    s_add_u32 s74, s73, 4096
    s_nop 0
    s_sleep 4
    buffer_load_dwordx4 v[192:195], v51, s[28:31], s73 offen offset:0 sc1
    buffer_load_dwordx4 v[196:199], v51, s[28:31], s73 offen offset:1024 sc1
    buffer_load_dwordx4 v[200:203], v51, s[28:31], s73 offen offset:2048 sc1
    buffer_load_dwordx4 v[204:207], v51, s[28:31], s73 offen offset:3072 sc1
    buffer_load_dwordx4 v[208:211], v51, s[28:31], s74 offen offset:0 sc1
    buffer_load_dwordx4 v[212:215], v51, s[28:31], s74 offen offset:1024 sc1
    buffer_load_dwordx4 v[216:219], v51, s[28:31], s74 offen offset:2048 sc1
    buffer_load_dwordx4 v[220:223], v51, s[28:31], s74 offen offset:3072 sc1
    s_waitcnt vmcnt(0)
    s_branch L_G1C
L_G1TO:
    s_mov_b32 s58, 0
L_G1OK:
    s_mov_b64 exec, -1
    s_mov_b32 s68, 0x3f80
    s_mov_b32 s69, 0x3f800000
    v_lshlrev_b32 v160, 16, v192
    v_and_b32 v161, 0xffff0000, v192
    v_lshlrev_b32 v162, 16, v194
    v_and_b32 v163, 0xffff0000, v194
    v_lshlrev_b32 v164, 16, v196
    v_and_b32 v165, 0xffff0000, v196
    v_lshlrev_b32 v166, 16, v198
    v_and_b32 v167, 0xffff0000, v198
    v_dot2c_f32_bf16 v160, s68, v200
    v_dot2c_f32_bf16 v161, s69, v200
    v_dot2c_f32_bf16 v162, s68, v202
    v_dot2c_f32_bf16 v163, s69, v202
    v_dot2c_f32_bf16 v164, s68, v204
    v_dot2c_f32_bf16 v165, s69, v204
    v_dot2c_f32_bf16 v166, s68, v206
    v_dot2c_f32_bf16 v167, s69, v206
    v_dot2c_f32_bf16 v160, s68, v208
    v_dot2c_f32_bf16 v161, s69, v208
    v_dot2c_f32_bf16 v162, s68, v210
    v_dot2c_f32_bf16 v163, s69, v210
    v_dot2c_f32_bf16 v164, s68, v212
    v_dot2c_f32_bf16 v165, s69, v212
    v_dot2c_f32_bf16 v166, s68, v214
    v_dot2c_f32_bf16 v167, s69, v214
    v_dot2c_f32_bf16 v160, s68, v216
    v_dot2c_f32_bf16 v161, s69, v216
    v_dot2c_f32_bf16 v162, s68, v218
    v_dot2c_f32_bf16 v163, s69, v218
    v_dot2c_f32_bf16 v164, s68, v220
    v_dot2c_f32_bf16 v165, s69, v220
    v_dot2c_f32_bf16 v166, s68, v222
    v_dot2c_f32_bf16 v167, s69, v222
    s_nop 2
    v_cvt_pk_bf16_f32 v44, v160, v161
    v_cvt_pk_bf16_f32 v45, v162, v163
    v_cvt_pk_bf16_f32 v46, v164, v165
    v_cvt_pk_bf16_f32 v47, v166, v167
    v_mov_b32_e64 v43, s55
    ds_write_b64 v48, v[44:45]
    ds_write_b64 v48, v[46:47] offset:544
    ds_write_b32 v40, v43 offset:20
    s_branch L_QREADY
    s_nop 0
L_STREAM:
    s_waitcnt lgkmcnt(0)
    s_cmp_lg_u32 s3, 3
    s_cbranch_scc1 L_NT
    s_lshl_b32 s68, s4, 19
    s_load_dword s52, s[16:17], s59
    s_load_dword s11, s[24:25], s68
    s_load_dword s10, s[36:37], 0
L_NT:
    s_cmp_lg_u32 s3, 2
    s_cbranch_scc1 L_NC
    s_add_u32 s55, s53, 0x9E3779B8
    s_or_b32 s55, s55, 1
    v_mov_b32 v47, s55
    ds_write_b32 v40, v47 offset:0
    v_mov_b32 v48, -1
    v_mov_b32 v49, -1
    v_mov_b32 v50, -1
    v_mov_b32 v51, -1
    v_lshlrev_b32_e64 v52, 4, v1
    s_mul_i32 s68, s7, 9216
    s_add_u32 s70, s68, 569344
    s_lshl_b32 s69, s5, 10
    s_add_u32 s68, s68, s69
    s_add_u32 s68, s68, 561152
    s_add_u32 s69, s68, 294912
    buffer_store_dwordx4 v[48:51], v52, s[28:31], s68 offen sc1
    buffer_store_dwordx4 v[48:51], v52, s[28:31], s69 offen sc1
    s_lshl_b32 s71, s5, 7
    s_add_u32 s68, s70, s71
    s_add_u32 s69, s68, 294912
    s_mov_b64 exec, 0xff
    buffer_store_dwordx4 v[48:51], v52, s[28:31], s68 offen sc1
    buffer_store_dwordx4 v[48:51], v52, s[28:31], s69 offen sc1
    s_lshl_b32 s68, s7, 10
    s_add_u32 s68, s68, s71
    s_add_u32 s69, s68, 528384
    buffer_store_dwordx4 v[48:51], v52, s[28:31], s69 offen sc1
    s_add_u32 s69, s85, 32768
    buffer_store_dwordx4 v[48:51], v52, s[28:31], s85 offen sc1
    buffer_store_dwordx4 v[48:51], v52, s[28:31], s69 offen sc1
    s_mov_b64 exec, -1
    s_getreg_b32 s69, hwreg(HW_REG_XCC_ID)
    s_and_b32 s69, s69, 15
    v_mov_b32 v46, s69
    s_lshr_b32 s76, s68, 1
    s_add_u32 s76, s76, 1314816
    s_add_u32 s77, s76, 16384
    s_waitcnt vmcnt(11)
    s_mov_b64 exec, 1
    ds_add_u32 v40, v41 offset:16
    s_mov_b64 exec, -1
    s_waitcnt vmcnt(10)
    s_add_u32 m0, s78, 4096
    s_nop 0
    buffer_load_dwordx4 v28, s[12:15], s88 offen offset:0 nt lds
    s_waitcnt vmcnt(10)
    buffer_load_dwordx4 v28, s[12:15], s88 offen offset:1024 nt lds
    s_waitcnt vmcnt(10)
    buffer_load_dwordx4 v29, s[12:15], s88 offen offset:2048 nt lds
    s_waitcnt vmcnt(10)
    buffer_load_dwordx4 v29, s[12:15], s88 offen offset:3072 nt lds
    s_waitcnt vmcnt(4)
    s_mov_b64 exec, 1
    buffer_store_dwordx2 v[46:47], off, s[28:31], s76
    buffer_store_dwordx2 v[46:47], off, s[28:31], s77 sc1
    s_mov_b64 exec, -1
    s_branch L_ST2
L_NC:
    s_waitcnt vmcnt(4)
    s_mov_b64 exec, 1
    ds_add_u32 v40, v41 offset:16
    s_mov_b64 exec, -1
    s_waitcnt vmcnt(3)
    s_add_u32 m0, s78, 4096
    s_nop 0
    buffer_load_dwordx4 v28, s[12:15], s88 offen offset:0 nt lds
    s_waitcnt vmcnt(3)
    buffer_load_dwordx4 v28, s[12:15], s88 offen offset:1024 nt lds
    s_waitcnt vmcnt(3)
    buffer_load_dwordx4 v29, s[12:15], s88 offen offset:2048 nt lds
    s_waitcnt vmcnt(3)
    buffer_load_dwordx4 v29, s[12:15], s88 offen offset:3072 nt lds
L_ST2:
    s_waitcnt vmcnt(3)
    s_add_u32 m0, s78, 32768
    s_nop 0
    buffer_load_dwordx4 v30, s[16:19], s59 offen offset:0 nt lds
    s_waitcnt vmcnt(3)
    s_add_u32 m0, s78, 32768
    s_nop 0
    buffer_load_dwordx4 v30, s[16:19], s59 offen offset:1024 nt lds
    s_waitcnt vmcnt(3)
    s_add_u32 m0, s78, 32768
    s_nop 0
    buffer_load_dwordx4 v31, s[16:19], s59 offen offset:2048 nt lds
    s_waitcnt vmcnt(3)
    s_add_u32 m0, s78, 32768
    s_nop 0
    buffer_load_dwordx4 v31, s[16:19], s59 offen offset:3072 nt lds
    s_waitcnt vmcnt(4)
    ds_read_b128 v[64:67], v33 offset:0
    ds_read_b128 v[68:71], v34 offset:0
    ds_read_b128 v[72:75], v35 offset:0
    ds_read_b128 v[76:79], v36 offset:0
    ds_read_b128 v[80:83], v33 offset:1024
    ds_read_b128 v[84:87], v34 offset:1024
    ds_read_b128 v[88:91], v35 offset:1024
    ds_read_b128 v[92:95], v36 offset:1024
    s_waitcnt lgkmcnt(0)
    s_lshl_b32 s73, s7, 9
    s_add_u32 s73, s73, 1314816
    v_lshlrev_b32 v42, 6, v1
    s_mov_b64 exec, 0xff
    buffer_load_dwordx2 v[56:57], v42, s[28:31], s73 offen sc1
    s_mov_b64 exec, -1
    s_waitcnt vmcnt(4)
    s_add_u32 m0, s78, 36864
    s_nop 0
    buffer_load_dwordx4 v30, s[16:19], s88 offen offset:0 nt lds
    s_mov_b64 exec, 1
    ds_add_u32 v40, v41 offset:36
    s_mov_b64 exec, -1
    s_waitcnt vmcnt(4)
    s_add_u32 m0, s78, 36864
    s_nop 0
    buffer_load_dwordx4 v30, s[16:19], s88 offen offset:1024 nt lds
    s_waitcnt vmcnt(4)
    s_add_u32 m0, s78, 36864
    s_nop 0
    buffer_load_dwordx4 v31, s[16:19], s88 offen offset:2048 nt lds
    s_waitcnt vmcnt(4)
    s_add_u32 m0, s78, 36864
    s_nop 0
    buffer_load_dwordx4 v31, s[16:19], s88 offen offset:3072 nt lds
    s_add_u32 s35, s6, 0
    s_and_b32 s35, s35, 3
    s_lshl_b32 s35, s35, 15
    s_add_u32 m0, s78, 70656
    s_nop 0
    buffer_load_dwordx4 v38, s[24:27], s35 offen offset:0 lds
    s_add_u32 s35, s35, 7168
    s_add_u32 m0, s78, 70656
    s_nop 0
    buffer_load_dwordx4 v39, s[24:27], s35 offen offset:1024 lds
    s_add_u32 s35, s35, 7168
    s_add_u32 m0, s78, 70656
    s_nop 0
    buffer_load_dwordx4 v38, s[24:27], s35 offen offset:2048 lds
    s_add_u32 s35, s35, 7168
    s_add_u32 m0, s78, 70656
    s_nop 0
    buffer_load_dwordx4 v39, s[24:27], s35 offen offset:3072 lds
    s_cmp_lg_u32 s3, 1
    s_cbranch_scc1 L_QREADY
L_sp7:
    ds_read_b32 v43, v40 offset:0
    s_waitcnt lgkmcnt(0)
    v_readfirstlane_b32 s55, v43
    s_nop 0
    s_cmp_ge_u32 s55, 1
    s_cbranch_scc1 L_spd8
    s_sub_u32 s58, s58, 1
    s_cbranch_scc0 L_sp7
    s_mov_b32 s58, 0
L_spd8:
    s_mov_b32 s71, 16384
    s_getreg_b32 s72, hwreg(HW_REG_XCC_ID)
    s_and_b32 s72, s72, 15
    s_mov_b64 exec, 0xff
    s_waitcnt vmcnt(8)
    s_branch L_GXC
L_GX:
    s_add_u32 s69, s73, s71
    s_xor_b32 s71, s71, 16384
    buffer_load_dwordx2 v[56:57], v42, s[28:31], s69 offen sc1
    s_waitcnt vmcnt(0)
L_GXC:
    v_cmp_ne_u32 vcc, s55, v57
    s_cbranch_vccz L_GXOK
    s_sleep 1
    s_sub_u32 s58, s58, 1
    s_cbranch_scc0 L_GX
    s_mov_b32 s58, 0
L_GXOK:
    v_cmp_ne_u32 vcc, s72, v56
    s_mov_b64 exec, -1
    s_cmp_eq_u64 vcc, 0
    s_cselect_b32 s70, 2, 1
    v_mov_b32 v43, s70
    ds_write_b32 v40, v43 offset:4
L_QREADY:
    s_lshl_b32 s68, s3, 5
    v_xor_b32_e64 v58, s68, v13
    v_add_u32 v59, 70656, v58
    s_setprio 3
L_QW:
    ds_read_b32 v46, v40 offset:20
    ds_read_b128 v[16:19], v32 offset:0
    ds_read_b128 v[24:27], v32 offset:64
    ds_read_b128 v[42:45], v32 offset:128
    ds_read_b128 v[50:53], v32 offset:192
    ds_read_b32 v10, v0
    s_waitcnt lgkmcnt(5)
    v_readfirstlane_b32 s55, v46
    s_nop 0
    s_cmp_lg_u32 s55, 0
    s_cbranch_scc1 L_QOK
    s_sleep 1
    s_sub_u32 s58, s58, 1
    s_cbranch_scc0 L_QW
    s_mov_b32 s58, 0
L_QOK:
    s_waitcnt lgkmcnt(0)
    v_mfma_f32_16x16x32_bf16 v[20:23], v[64:67], v[16:19], 0
    v_mfma_f32_16x16x32_bf16 v[28:31], v[80:83], v[16:19], 0
    v_mfma_f32_16x16x32_bf16 v[20:23], v[68:71], v[24:27], v[20:23]
    v_mfma_f32_16x16x32_bf16 v[28:31], v[84:87], v[24:27], v[28:31]
    v_mfma_f32_16x16x32_bf16 v[20:23], v[72:75], v[42:45], v[20:23]
    v_mfma_f32_16x16x32_bf16 v[28:31], v[88:91], v[42:45], v[28:31]
    v_mfma_f32_16x16x32_bf16 v[20:23], v[76:79], v[50:53], v[20:23]
    v_mfma_f32_16x16x32_bf16 v[28:31], v[92:95], v[50:53], v[28:31]
    v_and_b32 v11, 0xffff0000, v10
    v_lshlrev_b32_e64 v10, 16, v10
    v_mov_b32 v60, 0x3f803f80
    v_mov_b32 v61, 0x3f803f80
    v_mov_b32 v62, 0x3f803f80
    v_mov_b32 v63, 0x3f803f80
    ds_read_b64_tr_b16 v[128:129], v59 offset:32768
    ds_read_b64_tr_b16 v[130:131], v59 offset:33280
    ds_read_b64_tr_b16 v[132:133], v59 offset:36864
    ds_read_b64_tr_b16 v[134:135], v59 offset:37376
    ds_read_b64_tr_b16 v[136:137], v59 offset:40960
    ds_read_b64_tr_b16 v[138:139], v59 offset:41472
    ds_read_b64_tr_b16 v[140:141], v59 offset:45056
    ds_read_b64_tr_b16 v[142:143], v59 offset:45568
    s_nop 1
    s_branch L_ATT
L_AGW:
    s_nop 0
    s_waitcnt vmcnt(0)
    v_max3_u32 v56, v32, v33, v34
    v_max3_u32 v57, v35, v36, v37
    v_max3_u32 v58, v38, v39, v42
    v_max3_u32 v59, v43, v44, v45
    v_max3_u32 v56, v56, v49, v48
    v_max3_u32 v57, v57, v47, v46
    v_max3_u32 v56, v56, v59, v58
    v_max_u32 v56, v56, v57
    v_cmp_eq_u32 vcc, -1, v56
    s_nop 0
    s_and_b64 vcc, vcc, s[60:61]
    s_cbranch_scc1 L_ART
L_AOK:
    v_mfma_f32_16x16x32_bf16 v[20:23], v[64:67], v[32:35], 0
    v_mfma_f32_16x16x32_bf16 v[28:31], v[80:83], v[32:35], 0
    v_mfma_f32_16x16x32_bf16 v[20:23], v[68:71], v[36:39], v[20:23]
    v_mfma_f32_16x16x32_bf16 v[28:31], v[84:87], v[36:39], v[28:31]
    v_mfma_f32_16x16x32_bf16 v[20:23], v[72:75], v[42:45], v[20:23]
    v_mfma_f32_16x16x32_bf16 v[28:31], v[88:91], v[42:45], v[28:31]
    v_mfma_f32_16x16x32_bf16 v[20:23], v[76:79], v[46:49], v[20:23]
    v_mfma_f32_16x16x32_bf16 v[28:31], v[92:95], v[46:49], v[28:31]
L_ATT:
    s_nop 6
    v_max3_f32 v16, v20, v21, v22
    v_max3_f32 v17, v23, v28, v29
    v_max3_f32 v16, v16, v30, v31
    v_max_f32 v16, v16, v17
    v_mov_b32 v17, v16
    s_nop 1
    v_permlane32_swap_b32 v16, v17
    v_max_f32 v16, v16, v17
    v_mov_b32 v17, v16
    s_nop 1
    v_permlane16_swap_b32 v16, v17
    v_max_f32_e64 v16, v16, v17
    v_pk_add_f32 v[20:21], v[20:21], v[16:17] op_sel_hi:[1,0] neg_lo:[0,1] neg_hi:[0,1]
    v_pk_add_f32 v[22:23], v[22:23], v[16:17] op_sel_hi:[1,0] neg_lo:[0,1] neg_hi:[0,1]
    v_pk_add_f32 v[28:29], v[28:29], v[16:17] op_sel_hi:[1,0] neg_lo:[0,1] neg_hi:[0,1]
    v_pk_add_f32 v[30:31], v[30:31], v[16:17] op_sel_hi:[1,0] neg_lo:[0,1] neg_hi:[0,1]
    v_exp_f32 v20, v20
    v_exp_f32 v21, v21
    v_exp_f32 v22, v22
    v_exp_f32 v23, v23
    v_exp_f32 v28, v28
    v_exp_f32 v29, v29
    v_exp_f32 v30, v30
    v_exp_f32 v31, v31
    v_cvt_pk_bf16_f32 v24, v20, v21
    v_cvt_pk_bf16_f32 v25, v22, v23
    v_cvt_pk_bf16_f32 v26, v28, v29
    v_cvt_pk_bf16_f32 v27, v30, v31
    s_cmp_lg_u32 s57, 0
    s_cbranch_scc1 L_VRDR
L_sp9:
    ds_read_b32 v19, v40 offset:4
    s_waitcnt lgkmcnt(0)
    v_readfirstlane_b32 s56, v19
    s_nop 0
    s_cmp_ge_u32 s56, 1
    s_cbranch_scc1 L_spd10
    s_sleep 1
    s_sub_u32 s58, s58, 1
    s_cbranch_scc0 L_sp9
    s_mov_b32 s58, 0
L_spd10:
    s_add_u32 s35, s6, 1
    s_and_b32 s35, s35, 3
    s_lshl_b32 s35, s35, 15
    s_mov_b32 m0, s33
    s_nop 0
    buffer_load_dwordx4 v38, s[24:27], s35 offen offset:0 lds
    s_add_u32 s35, s35, 7168
    s_mov_b32 m0, s33
    s_nop 0
    buffer_load_dwordx4 v39, s[24:27], s35 offen offset:1024 lds
    s_add_u32 s35, s35, 7168
    s_mov_b32 m0, s33
    s_nop 0
    buffer_load_dwordx4 v38, s[24:27], s35 offen offset:2048 lds
    s_add_u32 s35, s35, 7168
    s_mov_b32 m0, s33
    s_nop 0
    buffer_load_dwordx4 v39, s[24:27], s35 offen offset:3072 lds
    s_nop 0
    s_waitcnt vmcnt(8)
    ds_read_b64_tr_b16 v[96:97], v37 offset:0
    ds_read_b64_tr_b16 v[98:99], v37 offset:1024
    v_xor_b32 v58, 128, v37
    ds_read_b64_tr_b16 v[112:113], v58 offset:0
    ds_read_b64_tr_b16 v[114:115], v58 offset:1024
    v_xor_b32_e64 v58, 32, v37
    ds_read_b64_tr_b16 v[100:101], v58 offset:0
    ds_read_b64_tr_b16 v[102:103], v58 offset:1024
    v_xor_b32 v58, 160, v37
    ds_read_b64_tr_b16 v[116:117], v58 offset:0
    ds_read_b64_tr_b16 v[118:119], v58 offset:1024
    v_xor_b32_e64 v58, 64, v37
    ds_read_b64_tr_b16 v[104:105], v58 offset:0
    ds_read_b64_tr_b16 v[106:107], v58 offset:1024
    v_xor_b32 v58, 192, v37
    ds_read_b64_tr_b16 v[120:121], v58 offset:0
    ds_read_b64_tr_b16 v[122:123], v58 offset:1024
    v_xor_b32 v58, 96, v37
    ds_read_b64_tr_b16 v[108:109], v58 offset:0
    ds_read_b64_tr_b16 v[110:111], v58 offset:1024
    v_xor_b32 v58, 224, v37
    ds_read_b64_tr_b16 v[124:125], v58 offset:0
    ds_read_b64_tr_b16 v[126:127], v58 offset:1024
L_VRDR:
    v_cndmask_b32 v24, 0, v24, s[60:61]
    v_cndmask_b32 v25, 0, v25, s[60:61]
    v_cndmask_b32 v26, 0, v26, s[60:61]
    v_cndmask_b32 v27, 0, v27, s[60:61]
    v_mov_b32_dpp v46, v24 row_shr:4 row_mask:0xf bank_mask:0xf bound_ctrl:0
    v_mov_b32_dpp v47, v25 row_shr:4 row_mask:0xf bank_mask:0xf bound_ctrl:0
    v_mov_b32_dpp v48, v26 row_shr:4 row_mask:0xf bank_mask:0xf bound_ctrl:0
    v_mov_b32_dpp v49, v27 row_shr:4 row_mask:0xf bank_mask:0xf bound_ctrl:0
    v_mfma_f32_16x16x32_bf16 v[20:23], v[60:63], v[24:27], 0
    s_waitcnt lgkmcnt(12)
    v_mfma_f32_16x16x32_bf16 v[50:53], v[96:99], v[24:27], 0
    v_mfma_f32_16x16x32_bf16 v[54:57], v[112:115], v[24:27], 0
    v_mov_b32_dpp v42, v24 row_shr:8 row_mask:0xf bank_mask:0xf bound_ctrl:0
    v_mov_b32_dpp v43, v25 row_shr:8 row_mask:0xf bank_mask:0xf bound_ctrl:0
    v_mov_b32_dpp v44, v26 row_shr:8 row_mask:0xf bank_mask:0xf bound_ctrl:0
    v_mov_b32_dpp v45, v27 row_shr:8 row_mask:0xf bank_mask:0xf bound_ctrl:0
    s_waitcnt lgkmcnt(8)
    v_mfma_f32_16x16x32_bf16 v[50:53], v[100:103], v[46:49], v[50:53]
    v_mfma_f32_16x16x32_bf16 v[54:57], v[116:119], v[46:49], v[54:57]
    v_mov_b32_dpp v46, v24 row_shr:12 row_mask:0xf bank_mask:0xf bound_ctrl:0
    v_mov_b32_dpp v47, v25 row_shr:12 row_mask:0xf bank_mask:0xf bound_ctrl:0
    v_mov_b32_dpp v48, v26 row_shr:12 row_mask:0xf bank_mask:0xf bound_ctrl:0
    v_mov_b32_dpp v49, v27 row_shr:12 row_mask:0xf bank_mask:0xf bound_ctrl:0
    s_waitcnt lgkmcnt(4)
    v_mfma_f32_16x16x32_bf16 v[50:53], v[104:107], v[42:45], v[50:53]
    v_mfma_f32_16x16x32_bf16 v[54:57], v[120:123], v[42:45], v[54:57]
    s_waitcnt lgkmcnt(0)
    v_mfma_f32_16x16x32_bf16 v[50:53], v[108:111], v[46:49], v[50:53]
    v_mfma_f32_16x16x32_bf16 v[54:57], v[124:127], v[46:49], v[54:57]
    s_mul_i32 s68, s3, 528
    s_add_u32 s68, s68, 120320
    v_mov_b32 v18, s68
    s_mov_b64 exec, 0xf
    ds_write2_b32 v6, v16, v20 offset0:128 offset1:129
    s_mov_b64 exec, -1
    s_nop 0
    ds_write_b128 v6, v[50:53]
    ds_write_b128 v6, v[54:57] offset:256
    s_cmp_lg_u32 s57, 0
    s_cbranch_scc1 L_SY1B
    s_mov_b64 exec, 1
    ds_add_u32 v40, v41 offset:8
    s_mov_b64 exec, -1
    s_add_u32 s35, s6, 2
    s_and_b32 s35, s35, 3
    s_lshl_b32 s35, s35, 15
    s_add_u32 m0, s78, 32768
    s_nop 0
    buffer_load_dwordx4 v38, s[24:27], s35 offen offset:0 lds
    s_add_u32 s35, s35, 7168
    s_add_u32 m0, s78, 32768
    s_nop 0
    buffer_load_dwordx4 v39, s[24:27], s35 offen offset:1024 lds
    s_add_u32 s35, s35, 7168
    s_add_u32 m0, s78, 32768
    s_nop 0
    buffer_load_dwordx4 v38, s[24:27], s35 offen offset:2048 lds
    s_add_u32 s35, s35, 7168
    s_add_u32 m0, s78, 32768
    s_nop 0
    buffer_load_dwordx4 v39, s[24:27], s35 offen offset:3072 lds
L_sp11:
    ds_read_b32 v19, v40 offset:8
    s_waitcnt lgkmcnt(0)
    v_readfirstlane_b32 s68, v19
    s_nop 0
    s_cmp_ge_u32 s68, 4
    s_cbranch_scc1 L_spd12
    s_sub_u32 s58, s58, 1
    s_cbranch_scc0 L_sp11
    s_mov_b32 s58, 0
L_spd12:
    s_branch L_SY1R
L_SY1B:
    s_waitcnt lgkmcnt(0)
    s_barrier
L_SY1R:
    ds_read_b64 v[20:21], v18 offset:0
    ds_read_b64 v[22:23], v18 offset:2112
    ds_read_b64 v[24:25], v18 offset:4224
    ds_read_b64 v[26:27], v18 offset:6336
    ds_read_b64 v[28:29], v7 offset:0
    ds_read_b64 v[30:31], v7 offset:2112
    ds_read_b64 v[32:33], v7 offset:4224
    ds_read_b64 v[34:35], v7 offset:6336
    s_lshl_b32 s68, s5, 3
    s_add_u32 s68, s82, s68
    s_waitcnt lgkmcnt(4)
    v_max3_f32 v16, v20, v22, v24
    v_max_f32 v16, v16, v26
    v_sub_f32 v20, v20, v16
    v_sub_f32 v22, v22, v16
    v_sub_f32 v24, v24, v16
    v_sub_f32 v26, v26, v16
    v_exp_f32 v20, v20
    v_exp_f32 v22, v22
    v_exp_f32 v24, v24
    v_exp_f32_e64 v26, v26
    s_waitcnt lgkmcnt(0)
    v_pk_mul_f32 v[42:43], v[28:29], v[20:21] op_sel_hi:[1,0]
    v_pk_fma_f32 v[42:43], v[30:31], v[22:23], v[42:43] op_sel_hi:[1,0,1]
    v_pk_fma_f32 v[42:43], v[32:33], v[24:25], v[42:43] op_sel_hi:[1,0,1]
    v_pk_fma_f32 v[42:43], v[34:35], v[26:27], v[42:43] op_sel_hi:[1,0,1]
    v_mul_f32 v17, v20, v21
    v_cvt_pk_bf16_f32 v42, v42, v43
    s_cmp_eq_u32 s56, 2
    s_cbranch_scc0 L_BPUB_SC1
    buffer_store_dword v42, v15, s[28:31], s81 offen
    v_fmac_f32 v17, v22, v23
    v_fmac_f32 v17, v24, v25
    v_fmac_f32 v17, v26, v27
    s_mov_b64 exec, 1
    buffer_store_dwordx2 v[16:17], off, s[28:31], s68
L_BPUB_R:
    s_cmp_lg_u32 s57, 0
    s_cbranch_scc1 L_BG0
    s_mov_b64 exec, -1
    s_add_u32 s35, s6, 3
    s_and_b32 s35, s35, 3
    s_lshl_b32 s35, s35, 15
    s_add_u32 m0, s78, 36864
    s_nop 0
    buffer_load_dwordx4 v38, s[24:27], s35 offen offset:0 lds
    s_add_u32 s35, s35, 7168
    s_add_u32 m0, s78, 36864
    s_nop 0
    buffer_load_dwordx4 v39, s[24:27], s35 offen offset:1024 lds
    s_add_u32 s35, s35, 7168
    s_add_u32 m0, s78, 36864
    s_nop 0
    buffer_load_dwordx4 v38, s[24:27], s35 offen offset:2048 lds
    s_add_u32 s35, s35, 7168
    s_add_u32 m0, s78, 36864
    s_nop 0
    buffer_load_dwordx4 v39, s[24:27], s35 offen offset:3072 lds
    s_mov_b64 exec, s[94:95]
    buffer_load_dwordx4 v[16:19], v4, s[28:31], s80 offen offset:0 sc1
    buffer_load_dwordx4 v[20:23], v4, s[28:31], s80 offen offset:512 sc1
    buffer_load_dwordx4 v[24:27], v4, s[28:31], s80 offen offset:1024 sc1
    buffer_load_dwordx4 v[28:31], v4, s[28:31], s80 offen offset:1536 sc1
    buffer_load_dwordx2 v[42:43], v5, s[28:31], s82 offen sc1
    s_mov_b64 exec, -1
    v_add_u32 v48, s78, v13
    v_add_u32 v44, 70656, v48
    v_add_u32 v52, s33, v13
    v_xor_b32 v45, 32, v44
    v_xor_b32 v49, 32, v48
    v_xor_b32 v53, 32, v52
    v_xor_b32 v46, 64, v44
    v_xor_b32 v50, 64, v48
    v_xor_b32_e64 v54, 64, v52
    v_xor_b32 v47, 96, v44
    v_xor_b32 v51, 96, v48
    v_xor_b32 v55, 96, v52
    s_nop 0
    s_waitcnt vmcnt(19)
    ds_read_b64_tr_b16 v[192:193], v44 offset:0
    ds_read_b64_tr_b16 v[194:195], v44 offset:512
    ds_read_b64_tr_b16 v[196:197], v45 offset:0
    ds_read_b64_tr_b16 v[198:199], v45 offset:512
    ds_read_b64_tr_b16 v[200:201], v46 offset:0
    ds_read_b64_tr_b16 v[202:203], v46 offset:512
    ds_read_b64_tr_b16 v[204:205], v47 offset:0
    ds_read_b64_tr_b16 v[206:207], v47 offset:512
    s_nop 0
    s_waitcnt vmcnt(15)
    ds_read_b64_tr_b16 v[208:209], v52 offset:0
    ds_read_b64_tr_b16 v[210:211], v52 offset:512
    ds_read_b64_tr_b16 v[212:213], v53 offset:0
    ds_read_b64_tr_b16 v[214:215], v53 offset:512
    ds_read_b64_tr_b16 v[216:217], v54 offset:0
    ds_read_b64_tr_b16 v[218:219], v54 offset:512
    ds_read_b64_tr_b16 v[220:221], v55 offset:0
    ds_read_b64_tr_b16 v[222:223], v55 offset:512
    s_nop 0
    s_waitcnt vmcnt(11)
    ds_read_b64_tr_b16 v[224:225], v48 offset:32768
    ds_read_b64_tr_b16 v[226:227], v48 offset:33280
    ds_read_b64_tr_b16 v[228:229], v49 offset:32768
    ds_read_b64_tr_b16 v[230:231], v49 offset:33280
    ds_read_b64_tr_b16 v[232:233], v50 offset:32768
    ds_read_b64_tr_b16 v[234:235], v50 offset:33280
    ds_read_b64_tr_b16 v[236:237], v51 offset:32768
    ds_read_b64_tr_b16 v[238:239], v51 offset:33280
    s_nop 0
    s_waitcnt vmcnt(5)
    ds_read_b64_tr_b16 v[240:241], v48 offset:36864
    ds_read_b64_tr_b16 v[242:243], v48 offset:37376
    ds_read_b64_tr_b16 v[244:245], v49 offset:36864
    ds_read_b64_tr_b16 v[246:247], v49 offset:37376
    ds_read_b64_tr_b16 v[248:249], v50 offset:36864
    ds_read_b64_tr_b16 v[250:251], v50 offset:37376
    ds_read_b64_tr_b16 v[252:253], v51 offset:36864
    ds_read_b64_tr_b16 v[254:255], v51 offset:37376
    s_waitcnt lgkmcnt(0)
    s_branch L_BGW
L_BG0:
    s_sleep 2
    s_mov_b64 exec, s[94:95]
    buffer_load_dwordx4 v[16:19], v4, s[28:31], s80 offen offset:0 sc1
    buffer_load_dwordx4 v[20:23], v4, s[28:31], s80 offen offset:512 sc1
    buffer_load_dwordx4 v[24:27], v4, s[28:31], s80 offen offset:1024 sc1
    buffer_load_dwordx4 v[28:31], v4, s[28:31], s80 offen offset:1536 sc1
    buffer_load_dwordx2 v[42:43], v5, s[28:31], s82 offen sc1
    s_mov_b64 exec, -1
L_BGW:
    s_waitcnt vmcnt(0)
    v_max3_u32 v34, v16, v17, v18
    v_max3_u32 v35, v19, v20, v21
    v_max3_u32 v36, v22, v23, v24
    v_max3_u32 v37, v25, v26, v27
    v_max3_u32 v34, v34, v43, v42
    v_max3_u32 v35, v35, v31, v30
    v_max3_u32 v36, v36, v29, v28
    v_max3_u32 v34, v34, v37, v36
    v_max_u32 v34, v34, v35
    v_cmp_eq_u32 vcc, -1, v34
    s_nop 0
    s_and_b64 vcc, vcc, s[94:95]
    s_cbranch_scc1 L_BRT
L_BOK:
    v_mfma_f32_16x16x32_bf16 v[44:47], v[16:19], v[192:195], 0
    v_max_f32_dpp v32, v42, v42 quad_perm:[1,0,3,2] row_mask:0xf bank_mask:0xf
    s_nop 1
    v_max_f32_dpp v32, v32, v32 quad_perm:[2,3,0,1] row_mask:0xf bank_mask:0xf
    v_mfma_f32_16x16x32_bf16 v[44:47], v[20:23], v[208:211], v[44:47]
    s_cmp_lg_u32 s57, 0
    s_cbranch_scc1 L_OP2
    s_mov_b64 exec, 1
    ds_add_u32 v40, v41 offset:32
    s_mov_b64 exec, -1
L_OP2:
    v_max_f32_dpp v32, v32, v32 row_half_mirror row_mask:0xf bank_mask:0xf
    v_mfma_f32_16x16x32_bf16 v[44:47], v[24:27], v[224:227], v[44:47]
    v_sub_f32 v42, v42, v32
    v_mfma_f32_16x16x32_bf16 v[44:47], v[28:31], v[240:243], v[44:47]
    v_exp_f32 v42, v42
    v_mfma_f32_16x16x32_bf16 v[48:51], v[16:19], v[196:199], 0
    v_mul_f32 v43, v42, v43
    v_mfma_f32_16x16x32_bf16 v[48:51], v[20:23], v[212:215], v[48:51]
    s_nop 0
    v_add_f32_dpp v43, v43, v43 quad_perm:[1,0,3,2] row_mask:0xf bank_mask:0xf
    v_mfma_f32_16x16x32_bf16 v[48:51], v[24:27], v[228:231], v[48:51]
    s_nop 0
    v_add_f32_dpp v43, v43, v43 quad_perm:[2,3,0,1] row_mask:0xf bank_mask:0xf
    v_mfma_f32_16x16x32_bf16 v[48:51], v[28:31], v[244:247], v[48:51]
    s_nop 0
    v_add_f32_dpp v43, v43, v43 row_half_mirror row_mask:0xf bank_mask:0xf
    v_mfma_f32_16x16x32_bf16 v[52:55], v[16:19], v[200:203], 0
    v_rcp_f32 v43, v43
    v_mfma_f32_16x16x32_bf16 v[52:55], v[20:23], v[216:219], v[52:55]
    v_mul_f32 v42, v42, v43
    v_mfma_f32_16x16x32_bf16 v[52:55], v[24:27], v[232:235], v[52:55]
    s_lshl_b32 s68, s3, 8
    s_add_u32 s68, s68, 161024
    v_add_u32 v43, s68, v2
    v_lshlrev_b32_e64 v33, 3, v1
    v_add_u32 v33, 161024, v33
    v_mfma_f32_16x16x32_bf16 v[52:55], v[28:31], v[248:251], v[52:55]
    v_mul_f32_dpp v34, v42, v44 row_newbcast:0 row_mask:0xf bank_mask:0xf
    v_fmac_f32_dpp v34, v42, v45 row_newbcast:1 row_mask:0xf bank_mask:0xf
    v_mfma_f32_16x16x32_bf16 v[56:59], v[16:19], v[204:207], 0
    v_fmac_f32_dpp v34, v42, v46 row_newbcast:2 row_mask:0xf bank_mask:0xf
    v_fmac_f32_dpp v34, v42, v47 row_newbcast:3 row_mask:0xf bank_mask:0xf
    v_mfma_f32_16x16x32_bf16 v[56:59], v[20:23], v[220:223], v[56:59]
    v_mul_f32_dpp v35, v42, v48 row_newbcast:0 row_mask:0xf bank_mask:0xf
    v_fmac_f32_dpp v35, v42, v49 row_newbcast:1 row_mask:0xf bank_mask:0xf
    v_mfma_f32_16x16x32_bf16 v[56:59], v[24:27], v[236:239], v[56:59]
    v_fmac_f32_dpp v35, v42, v50 row_newbcast:2 row_mask:0xf bank_mask:0xf
    v_fmac_f32_dpp v35, v42, v51 row_newbcast:3 row_mask:0xf bank_mask:0xf
    v_mfma_f32_16x16x32_bf16 v[56:59], v[28:31], v[252:255], v[56:59]
    v_mul_f32_dpp v36, v42, v52 row_newbcast:0 row_mask:0xf bank_mask:0xf
    v_fmac_f32_dpp v36, v42, v53 row_newbcast:1 row_mask:0xf bank_mask:0xf
    v_fmac_f32_dpp v36, v42, v54 row_newbcast:2 row_mask:0xf bank_mask:0xf
    v_fmac_f32_dpp v36, v42, v55 row_newbcast:3 row_mask:0xf bank_mask:0xf
    v_permlane16_swap_b32 v34, v35
    v_add_f32_e64 v16, v34, v35
    s_nop 1
    v_mul_f32_dpp v37, v42, v56 row_newbcast:0 row_mask:0xf bank_mask:0xf
    v_fmac_f32_dpp v37, v42, v57 row_newbcast:1 row_mask:0xf bank_mask:0xf
    v_fmac_f32_dpp v37, v42, v58 row_newbcast:2 row_mask:0xf bank_mask:0xf
    v_fmac_f32_dpp v37, v42, v59 row_newbcast:3 row_mask:0xf bank_mask:0xf
    s_nop 1
    v_permlane16_swap_b32 v36, v37
    v_add_f32 v18, v36, v37
    s_nop 1
    v_permlane32_swap_b32 v16, v18
    ds_write_b32 v43, v16
    s_waitcnt lgkmcnt(0)
    s_nop 0
    s_barrier
L_SY2R:
    s_cmp_lg_u32 s3, 0
    s_cbranch_scc1 L_CPUB_R
    ds_read_b64 v[22:23], v33 offset:0
    ds_read_b64 v[24:25], v33 offset:256
    ds_read_b64 v[26:27], v33 offset:512
    ds_read_b64 v[28:29], v33 offset:768
    s_mov_b32 exec_hi, 0
    s_waitcnt lgkmcnt(0)
    v_pk_add_f32 v[22:23], v[22:23], v[24:25]
    v_pk_add_f32 v[26:27], v[26:27], v[28:29]
    v_pk_add_f32 v[22:23], v[22:23], v[26:27]
    v_cvt_pk_bf16_f32 v32, v22, v23
    buffer_store_dword v32, v2, s[28:31], s85 offen sc1
    s_mov_b32 exec_hi, -1
L_CPUB_R:
    s_cmp_lg_u32 s57, 0
    s_cbranch_scc1 L_C2
    s_lshl_b32 s68, s3, 5
    v_xor_b32_e64 v22, s68, v13
    v_add_u32 v23, 70656, v22
    ds_read_b64_tr_b16 v[144:145], v22 offset:0
    ds_read_b64_tr_b16 v[146:147], v22 offset:512
    ds_read_b64_tr_b16 v[148:149], v22 offset:4096
    ds_read_b64_tr_b16 v[150:151], v22 offset:4608
    ds_read_b64_tr_b16 v[152:153], v23 offset:4096
    ds_read_b64_tr_b16 v[154:155], v23 offset:4608
    ds_read_b64_tr_b16 v[156:157], v22 offset:8192
    ds_read_b64_tr_b16 v[158:159], v22 offset:8704
    ds_read_b64_tr_b16 v[160:161], v22 offset:12288
    ds_read_b64_tr_b16 v[162:163], v22 offset:12800
    ds_read_b64_tr_b16 v[164:165], v23 offset:12288
    ds_read_b64_tr_b16 v[166:167], v23 offset:12800
    ds_read_b64_tr_b16 v[168:169], v22 offset:16384
    ds_read_b64_tr_b16 v[170:171], v22 offset:16896
    ds_read_b64_tr_b16 v[172:173], v22 offset:20480
    ds_read_b64_tr_b16 v[174:175], v22 offset:20992
    ds_read_b64_tr_b16 v[176:177], v23 offset:20480
    ds_read_b64_tr_b16 v[178:179], v23 offset:20992
    ds_read_b64_tr_b16 v[180:181], v22 offset:24576
    ds_read_b64_tr_b16 v[182:183], v22 offset:25088
    ds_read_b64_tr_b16 v[184:185], v22 offset:28672
    ds_read_b64_tr_b16 v[186:187], v22 offset:29184
    ds_read_b64_tr_b16 v[188:189], v23 offset:28672
    ds_read_b64_tr_b16 v[190:191], v23 offset:29184
    v_mov_b32 v21, 0x3f803f80
    v_cndmask_b32 v32, 0, v21, s[60:61]
    v_cndmask_b32 v33, 0, v21, s[60:61]
    v_cndmask_b32 v34, 0, v21, s[60:61]
    v_cndmask_b32 v35, 0, v21, s[60:61]
    s_nop 1
    v_mfma_f32_16x16x32_bf16 v[44:47], v[32:35], v[128:131], 0
    v_mfma_f32_16x16x32_bf16 v[48:51], v[32:35], v[132:135], 0
    v_mfma_f32_16x16x32_bf16 v[52:55], v[32:35], v[136:139], 0
    v_mfma_f32_16x16x32_bf16 v[56:59], v[32:35], v[140:143], 0
    v_cndmask_b32 v36, 0, v21, s[62:63]
    v_cndmask_b32 v37, 0, v21, s[62:63]
    v_cndmask_b32 v38, 0, v21, s[62:63]
    v_cndmask_b32 v39, 0, v21, s[62:63]
    s_waitcnt lgkmcnt(15)
    s_nop 0
    v_mfma_f32_16x16x32_bf16 v[44:47], v[36:39], v[144:147], v[44:47]
    v_mfma_f32_16x16x32_bf16 v[48:51], v[36:39], v[148:151], v[48:51]
    v_mfma_f32_16x16x32_bf16 v[52:55], v[36:39], v[152:155], v[52:55]
    v_mfma_f32_16x16x32_bf16 v[56:59], v[36:39], v[156:159], v[56:59]
    v_cndmask_b32 v32, 0, v21, s[64:65]
    v_cndmask_b32 v33, 0, v21, s[64:65]
    v_cndmask_b32 v34, 0, v21, s[64:65]
    v_cndmask_b32 v35, 0, v21, s[64:65]
    s_waitcnt lgkmcnt(8)
    s_nop 0
    v_mfma_f32_16x16x32_bf16 v[44:47], v[32:35], v[160:163], v[44:47]
    v_mfma_f32_16x16x32_bf16 v[48:51], v[32:35], v[164:167], v[48:51]
    v_mfma_f32_16x16x32_bf16 v[52:55], v[32:35], v[168:171], v[52:55]
    v_mfma_f32_16x16x32_bf16 v[56:59], v[32:35], v[172:175], v[56:59]
    v_cndmask_b32 v36, 0, v21, s[66:67]
    v_cndmask_b32 v37, 0, v21, s[66:67]
    v_cndmask_b32 v38, 0, v21, s[66:67]
    v_cndmask_b32 v39, 0, v21, s[66:67]
    s_waitcnt lgkmcnt(0)
    s_nop 0
    v_mfma_f32_16x16x32_bf16 v[44:47], v[36:39], v[176:179], v[44:47]
    v_mfma_f32_16x16x32_bf16 v[48:51], v[36:39], v[180:183], v[48:51]
    v_mfma_f32_16x16x32_bf16 v[52:55], v[36:39], v[184:187], v[52:55]
    v_mfma_f32_16x16x32_bf16 v[56:59], v[36:39], v[188:191], v[56:59]
    s_nop 5
    v_add_f32 v26, v44, v49
    s_nop 0
    v_add_f32 v27, v54, v59
    v_add_f32 v26, v26, v27
    v_mov_b32 v27, v26
    s_nop 1
    v_permlane16_swap_b32 v26, v27
    v_add_f32 v26, v26, v27
    v_mov_b32 v27, v26
    s_nop 1
    v_permlane32_swap_b32 v26, v27
    v_add_f32 v12, v26, v27
L_sp13:
    ds_read_b32 v19, v40 offset:44
    s_waitcnt lgkmcnt(0)
    v_readfirstlane_b32 s68, v19
    s_nop 0
    s_cmp_ge_u32 s68, 1
    s_cbranch_scc1 L_spd14
    s_sleep 1
    s_sub_u32 s58, s58, 1
    s_cbranch_scc0 L_sp13
    s_mov_b32 s58, 0
L_spd14:
    s_sleep 6
    s_branch L_CG0
L_C2:
    s_lshl_b32 s68, s6, 1
    s_cmp_lg_u32 s68, s4
    s_cbranch_scc1 L_WB
    s_cmp_lg_u32 s5, 0
    s_cbranch_scc1 L_WB
    ds_read_b64 v[10:11], v8 offset:2304
    v_subrev_u32 v0, 152576, v9
    v_and_b32 v25, 0xf0, v0
    v_lshrrev_b32 v0, 8, v0
    v_lshlrev_b32 v0, 4, v0
    v_lshl_add_u32 v0, v25, 2, v0
    s_lshl_b32 s34, s6, 10
    s_sleep 5
L_CG0:
    s_lshl_b32 s68, s3, 3
    s_add_u32 s68, s68, 154624
    v_mov_b32 v50, s68
    v_mov_b32 v51, 154624
    v_mov_b32 v42, 0
    v_mov_b32 v43, 0
    v_mov_b32 v44, 0
    v_mov_b32 v45, 0
    v_mov_b32 v46, 0
    v_mov_b32 v47, 0
    v_mov_b32 v48, 0
    v_mov_b32 v49, 0
    v_mov_b32 v17, 0
    v_mov_b32_e64 v19, 0
    s_mov_b32 s32, 0x3f80
    s_mov_b32 s33, 0x3f800000
    buffer_load_dword v16, v2, s[28:31], s83 offen offset:0 sc1
    buffer_load_dword v18, v2, s[28:31], s83 offen offset:1024 sc1
    buffer_load_dword v20, v2, s[28:31], s83 offen offset:2048 sc1
    buffer_load_dword v22, v2, s[28:31], s83 offen offset:3072 sc1
    buffer_load_dword v24, v2, s[28:31], s84 offen offset:0 sc1
    buffer_load_dword v26, v2, s[28:31], s84 offen offset:1024 sc1
    buffer_load_dword v28, v2, s[28:31], s84 offen offset:2048 sc1
    buffer_load_dword v30, v2, s[28:31], s84 offen offset:3072 sc1
L_CG:
    s_nop 0
    s_waitcnt vmcnt(0) lgkmcnt(0)
    v_cmp_eq_u32 s[68:69], -1, v16
    v_cmp_eq_u32 s[70:71], -1, v18
    v_cmp_eq_u32 s[72:73], -1, v20
    v_cmp_eq_u32 s[74:75], -1, v22
    v_cmp_eq_u32 s[76:77], -1, v24
    v_cmp_eq_u32 s[78:79], -1, v26
    v_cmp_eq_u32 s[8:9], -1, v28
    v_cmp_eq_u32 s[10:11], -1, v30
    s_or_b64 s[52:53], s[68:69], s[70:71]
    s_or_b64 vcc, s[72:73], s[74:75]
    s_or_b64 s[52:53], s[52:53], vcc
    s_or_b64 vcc, s[76:77], s[78:79]
    s_or_b64 s[52:53], s[52:53], vcc
    s_or_b64 vcc, s[8:9], s[10:11]
    s_or_b64 s[52:53], s[52:53], vcc
    s_cbranch_scc1 L_CRT
L_COK:
    v_dot2c_f32_bf16 v10, s32, v16
    v_dot2c_f32_bf16 v11, s33, v16
    v_dot2c_f32_bf16 v17, s32, v24
    v_dot2c_f32_bf16 v19, s33, v24
    v_dot2c_f32_bf16 v10, s32, v18
    v_dot2c_f32_bf16 v11, s33, v18
    v_dot2c_f32_bf16 v17, s32, v26
    v_dot2c_f32_bf16 v19, s33, v26
    v_dot2c_f32_bf16 v10, s32, v20
    v_dot2c_f32_bf16 v11, s33, v20
    v_dot2c_f32_bf16 v17, s32, v28
    v_dot2c_f32_bf16 v19, s33, v28
    v_dot2c_f32_bf16 v10, s32, v22
    v_dot2c_f32_bf16 v11, s33, v22
    v_dot2c_f32_bf16 v17, s32, v30
    v_dot2c_f32_bf16 v19, s33, v30
    v_mov_b32 v22, 989855744
    s_nop 1
    v_add_f32 v24, v17, v10
    v_add_f32 v25, v19, v11
    ds_write_b64 v8, v[24:25]
    v_pk_mul_f32 v[20:21], v[24:25], v[22:23] op_sel_hi:[1,0]
    v_add_f32 v26, v20, v21
    v_mul_f32 v27, v24, v20
    v_fmac_f32 v27, v25, v21
    v_add_f32_dpp v26, v26, v26 row_shr:1 row_mask:0xf bank_mask:0xf
    s_nop 0
    v_add_f32_dpp v27, v27, v27 row_shr:1 row_mask:0xf bank_mask:0xf
    v_add_f32_dpp v26, v26, v26 row_shr:2 row_mask:0xf bank_mask:0xf
    s_nop 0
    v_add_f32_dpp v27, v27, v27 row_shr:2 row_mask:0xf bank_mask:0xf
    v_add_f32_dpp v26, v26, v26 row_shr:4 row_mask:0xf bank_mask:0xf
    s_nop 0
    v_add_f32_dpp v27, v27, v27 row_shr:4 row_mask:0xf bank_mask:0xf
    v_add_f32_dpp v26, v26, v26 row_shr:8 row_mask:0xf bank_mask:0xf
    s_nop 0
    v_add_f32_dpp v27, v27, v27 row_shr:8 row_mask:0xf bank_mask:0xf
    v_add_f32_dpp v26, v26, v26 row_bcast:15 row_mask:0xa bank_mask:0xf
    s_nop 0
    v_add_f32_dpp v27, v27, v27 row_bcast:15 row_mask:0xa bank_mask:0xf
    v_add_f32_dpp v26, v26, v26 row_bcast:31 row_mask:0xc bank_mask:0xf
    s_nop 0
    v_add_f32_dpp v27, v27, v27 row_bcast:31 row_mask:0xc bank_mask:0xf
    s_mov_b32 exec_lo, 0
    s_mov_b32 exec_hi, 0x80000000
    ds_write_b64 v50, v[26:27]
    s_mov_b64 exec, -1
    s_waitcnt lgkmcnt(0)
    s_barrier
    ds_read_b128 v[24:27], v51
    ds_read_b128 v[28:31], v51 offset:16
    ds_read_b128 v[16:19], v9
    ds_read_b128 v[20:23], v9 offset:1024
    v_mov_b32 v32, 786163455
    s_mov_b32 s68, 0x7fff7fff
    s_mov_b32 s69, 922760960
    s_mov_b32 s70, 2560
    s_waitcnt lgkmcnt(2)
    v_pk_add_f32 v[24:25], v[24:25], v[26:27]
    v_pk_add_f32 v[28:29], v[28:29], v[30:31]
    v_pk_add_f32 v[24:25], v[24:25], v[28:29]
    v_fma_f32 v25, -v24, v24, v25
    v_max_f32 v25, 0, v25
    v_fmac_f32 v32, 1065353300, v25
    v_rsq_f32 v26, v32
    s_waitcnt lgkmcnt(0)
    v_mul_f32_e64 v24, v24, v26
    v_pk_fma_f32 v[32:33], v[16:17], v[26:27], v[24:25] op_sel_hi:[1,0,0] neg_lo:[0,0,1] neg_hi:[0,0,1]
    v_pk_fma_f32 v[34:35], v[18:19], v[26:27], v[24:25] op_sel_hi:[1,0,0] neg_lo:[0,0,1] neg_hi:[0,0,1]
    v_pk_fma_f32 v[36:37], v[20:21], v[26:27], v[24:25] op_sel_hi:[1,0,0] neg_lo:[0,0,1] neg_hi:[0,0,1]
    v_pk_fma_f32 v[38:39], v[22:23], v[26:27], v[24:25] op_sel_hi:[1,0,0] neg_lo:[0,0,1] neg_hi:[0,0,1]
    v_cvt_pk_bf16_f32 v28, v32, v33
    v_cvt_pk_bf16_f32 v29, v34, v35
    v_cvt_pk_bf16_f32 v30, v36, v37
    v_cvt_pk_bf16_f32 v31, v38, v39
    v_lshlrev_b32_sdwa v32, 1, v28 dst_sel:DWORD dst_unused:UNUSED_PAD src0_sel:DWORD src1_sel:WORD_0
    ds_read_u16_d16_hi v42, v32 offset:37376
    v_lshlrev_b32_sdwa v33, 1, v28 dst_sel:DWORD dst_unused:UNUSED_PAD src0_sel:DWORD src1_sel:WORD_1
    ds_read_u16_d16_hi v43, v33 offset:37376
    v_lshlrev_b32_sdwa v34, 1, v29 dst_sel:DWORD dst_unused:UNUSED_PAD src0_sel:DWORD src1_sel:WORD_0
    ds_read_u16_d16_hi v44, v34 offset:37376
    v_lshlrev_b32_sdwa v35, 1, v29 dst_sel:DWORD dst_unused:UNUSED_PAD src0_sel:DWORD src1_sel:WORD_1
    ds_read_u16_d16_hi v45, v35 offset:37376
    v_lshlrev_b32_sdwa v36, 1, v30 dst_sel:DWORD dst_unused:UNUSED_PAD src0_sel:DWORD src1_sel:WORD_0
    ds_read_u16_d16_hi v46, v36 offset:37376
    v_lshlrev_b32_sdwa v37, 1, v30 dst_sel:DWORD dst_unused:UNUSED_PAD src0_sel:DWORD src1_sel:WORD_1
    ds_read_u16_d16_hi v47, v37 offset:37376
    v_lshlrev_b32_sdwa v38, 1, v31 dst_sel:DWORD dst_unused:UNUSED_PAD src0_sel:DWORD src1_sel:WORD_0
    ds_read_u16_d16_hi v48, v38 offset:37376
    v_lshlrev_b32_sdwa v39, 1, v31 dst_sel:DWORD dst_unused:UNUSED_PAD src0_sel:DWORD src1_sel:WORD_1
    ds_read_u16_d16_hi v49, v39 offset:37376
    v_and_b32 v24, s68, v28
    v_pk_sub_u16 v24, v24, s69
    v_and_b32 v25, s68, v29
    v_pk_sub_u16 v25, v25, s69
    v_and_b32 v26, s68, v30
    v_pk_sub_u16 v26, v26, s69
    v_and_b32 v27, s68, v31
    v_pk_sub_u16 v27, v27, s69
    v_pk_max_u16 v24, v24, v25
    v_pk_max_u16 v26, v26, v27
    v_pk_max_u16 v24, v24, v26
    v_max_u16_sdwa v24, v24, v24 dst_sel:DWORD dst_unused:UNUSED_PAD src0_sel:WORD_0 src1_sel:WORD_1
    v_cmp_le_u32_e64 vcc, s70, v24
    s_waitcnt lgkmcnt(0)
    s_cbranch_vccnz L_FB
L_FBR:
    v_pk_add_f32 v[16:17], v[16:17], v[42:43]
    v_pk_add_f32 v[18:19], v[18:19], v[44:45]
    v_pk_add_f32 v[20:21], v[20:21], v[46:47]
    v_pk_add_f32 v[22:23], v[22:23], v[48:49]
    v_cvt_pk_bf16_f32 v28, v16, v17
    v_cvt_pk_bf16_f32 v29, v18, v19
    v_cvt_pk_bf16_f32 v30, v20, v21
    v_cvt_pk_bf16_f32 v31, v22, v23
    s_cmp_eq_u32 s57, 0
    s_cbranch_scc0 L_OUT
    v_cndmask_b32 v32, 0, v28, s[60:61]
    v_cndmask_b32 v33, 0, v29, s[60:61]
    v_cndmask_b32 v34, 0, v30, s[60:61]
    v_cndmask_b32 v35, 0, v31, s[60:61]
    v_pk_add_f32 v[24:25], v[16:17], v[18:19]
    v_pk_mul_f32 v[26:27], v[16:17], v[16:17]
    v_mfma_f32_16x16x32_bf16 v[44:47], v[32:35], v[128:131], 0
    v_cndmask_b32 v36, 0, v28, s[62:63]
    v_pk_add_f32 v[40:41], v[20:21], v[22:23]
    v_pk_fma_f32 v[26:27], v[18:19], v[18:19], v[26:27]
    v_mfma_f32_16x16x32_bf16 v[48:51], v[32:35], v[132:135], 0
    v_cndmask_b32 v37, 0, v29, s[62:63]
    v_pk_add_f32 v[24:25], v[24:25], v[40:41]
    v_pk_fma_f32 v[26:27], v[20:21], v[20:21], v[26:27]
    v_mfma_f32_16x16x32_bf16 v[52:55], v[32:35], v[136:139], 0
    v_cndmask_b32 v38, 0, v30, s[62:63]
    v_add_f32 v24, v24, v25
    v_pk_fma_f32 v[26:27], v[22:23], v[22:23], v[26:27]
    v_mfma_f32_16x16x32_bf16 v[56:59], v[32:35], v[140:143], 0
    v_cndmask_b32 v39, 0, v31, s[62:63]
    v_add_f32 v25, v26, v27
    v_add_f32_dpp v24, v24, v24 row_ror:8 row_mask:0xf bank_mask:0xf
    v_mfma_f32_16x16x32_bf16 v[44:47], v[36:39], v[144:147], v[44:47]
    v_cndmask_b32 v32, 0, v28, s[64:65]
    v_add_f32_dpp v25, v25, v25 row_ror:8 row_mask:0xf bank_mask:0xf
    v_add_f32_dpp v24, v24, v24 row_ror:4 row_mask:0xf bank_mask:0xf
    v_mfma_f32_16x16x32_bf16 v[48:51], v[36:39], v[148:151], v[48:51]
    v_cndmask_b32 v33, 0, v29, s[64:65]
    v_add_f32_dpp v25, v25, v25 row_ror:4 row_mask:0xf bank_mask:0xf
    v_add_f32_dpp v24, v24, v24 row_ror:2 row_mask:0xf bank_mask:0xf
    v_mfma_f32_16x16x32_bf16 v[52:55], v[36:39], v[152:155], v[52:55]
    v_cndmask_b32 v34, 0, v30, s[64:65]
    v_add_f32_dpp v25, v25, v25 row_ror:2 row_mask:0xf bank_mask:0xf
    v_add_f32_dpp v24, v24, v24 row_ror:1 row_mask:0xf bank_mask:0xf
    v_mfma_f32_16x16x32_bf16 v[56:59], v[36:39], v[156:159], v[56:59]
    v_cndmask_b32 v35, 0, v31, s[64:65]
    v_add_f32_dpp v25, v25, v25 row_ror:1 row_mask:0xf bank_mask:0xf
    v_mov_b32 v26, v24
    v_mfma_f32_16x16x32_bf16 v[44:47], v[32:35], v[160:163], v[44:47]
    v_cndmask_b32 v36, 0, v28, s[66:67]
    v_mov_b32 v27, v25
    v_permlane16_swap_b32 v24, v26
    v_mfma_f32_16x16x32_bf16 v[48:51], v[32:35], v[164:167], v[48:51]
    v_cndmask_b32 v37, 0, v29, s[66:67]
    v_permlane16_swap_b32 v25, v27
    v_pk_add_f32 v[24:25], v[24:25], v[26:27]
    v_mfma_f32_16x16x32_bf16 v[52:55], v[32:35], v[168:171], v[52:55]
    v_cndmask_b32 v38, 0, v30, s[66:67]
    v_mov_b32 v26, v24
    v_mov_b32 v27, v25
    v_mfma_f32_16x16x32_bf16 v[56:59], v[32:35], v[172:175], v[56:59]
    v_cndmask_b32 v39, 0, v31, s[66:67]
    v_permlane32_swap_b32 v24, v26
    v_permlane32_swap_b32 v25, v27
    v_mfma_f32_16x16x32_bf16 v[44:47], v[36:39], v[176:179], v[44:47]
    v_pk_add_f32 v[24:25], v[24:25], v[26:27]
    v_mul_f32 v24, 989855744, v24
    v_mfma_f32_16x16x32_bf16 v[48:51], v[36:39], v[180:183], v[48:51]
    v_mul_f32 v25, 989855744, v25
    v_fma_f32 v25, -v24, v24, v25
    v_mfma_f32_16x16x32_bf16 v[52:55], v[36:39], v[184:187], v[52:55]
    v_max_f32 v25, 0, v25
    v_add_f32 v25, 925353388, v25
    v_mfma_f32_16x16x32_bf16 v[56:59], v[36:39], v[188:191], v[56:59]
    v_rsq_f32 v25, v25
    v_and_b32 v28, 7, v1
    v_lshlrev_b32 v28, 1, v28
    v_bfe_u32 v29, v1, 3, 1
    v_lshl_add_u32 v28, v29, 6, v28
    v_mul_f32 v25, 1040356334, v25
    v_add_f32 v26, v44, v49
    s_nop 0
    v_add_f32 v27, v54, v59
    v_add_f32 v26, v26, v27
    v_mov_b32 v27, v26
    s_nop 1
    v_permlane16_swap_b32 v26, v27
    v_add_f32 v26, v26, v27
    v_mov_b32 v27, v26
    s_nop 1
    v_permlane32_swap_b32 v26, v27
    v_add_f32 v26, v26, v27
    v_fma_f32 v26, -v24, v12, v26
    v_mul_f32_e64 v26, v26, v25
    s_cmp_eq_u32 s56, 2
    s_nop 0
    v_mov_b32_dpp v27, v26 quad_perm:[1,0,3,2] row_mask:0xf bank_mask:0xf
    v_cvt_pk_bf16_f32 v26, v26, v27
    s_mov_b64 exec, 0x5555
    s_cbranch_scc0 L_APUB_SC1
    buffer_store_dword v26, v28, s[28:31], s87 offen
L_APUB_R:
    s_nop 0
    s_sleep 2
    s_mov_b64 exec, s[60:61]
    buffer_load_dwordx4 v[32:35], v3, s[28:31], s86 offen offset:0 sc1
    buffer_load_dwordx4 v[36:39], v3, s[28:31], s86 offen offset:256 sc1
    buffer_load_dwordx4 v[42:45], v3, s[28:31], s86 offen offset:512 sc1
    buffer_load_dwordx4 v[46:49], v3, s[28:31], s86 offen offset:768 sc1
    s_mov_b64 exec, -1
    ds_write_b128 v9, v[16:19] offset:2304
    ds_write_b128 v9, v[20:23] offset:3328
    s_mov_b32 s57, 1
    s_or_b32 s68, s2, s3
    s_cbranch_scc0 L_EPO
L_EPOR:
    s_add_u32 s80, s80, 294912
    s_add_u32 s81, s81, 294912
    s_add_u32 s82, s82, 294912
    s_add_u32 s83, s83, 32768
    s_add_u32 s84, s84, 32768
    s_add_u32 s85, s85, 32768
    s_branch L_AGW
L_OUT:
    s_cmp_lg_u32 s3, 0
    s_cbranch_scc1 L_FIN
    buffer_store_dwordx4 v[28:31], v0, s[36:39], s34 offen
L_FIN:
L_END:
    s_endpgm
L_WB:
    s_branch L_FIN
L_ART:
    s_sub_u32 s58, s58, 1
    s_cbranch_scc1 L_ATO
    s_mov_b64 exec, vcc
    buffer_load_dwordx4 v[32:35], v3, s[28:31], s86 offen offset:0 sc1
    buffer_load_dwordx4 v[36:39], v3, s[28:31], s86 offen offset:256 sc1
    buffer_load_dwordx4 v[42:45], v3, s[28:31], s86 offen offset:512 sc1
    buffer_load_dwordx4 v[46:49], v3, s[28:31], s86 offen offset:768 sc1
    s_mov_b64 exec, -1
    s_branch L_AGW
L_ATO:
    s_mov_b32 s58, 0
    s_branch L_AOK
    s_nop 0
L_BRT:
    s_sub_u32 s58, s58, 1
    s_cbranch_scc1 L_BTO
    s_mov_b64 exec, vcc
    buffer_load_dwordx4 v[16:19], v4, s[28:31], s80 offen offset:0 sc1
    buffer_load_dwordx4 v[20:23], v4, s[28:31], s80 offen offset:512 sc1
    buffer_load_dwordx4 v[24:27], v4, s[28:31], s80 offen offset:1024 sc1
    buffer_load_dwordx4 v[28:31], v4, s[28:31], s80 offen offset:1536 sc1
    buffer_load_dwordx2 v[42:43], v5, s[28:31], s82 offen sc1
    s_mov_b64 exec, -1
    s_branch L_BGW
L_BTO:
    s_mov_b32 s58, 0
    s_branch L_BOK
L_CRT:
    s_sub_u32 s58, s58, 1
    s_cbranch_scc1 L_CTO
    s_sleep 0
    s_cmp_eq_u64 s[68:69], 0
    s_cbranch_scc1 L_CS0
    buffer_load_dword v16, v2, s[28:31], s83 offen offset:0 sc1
L_CS0:
    s_cmp_eq_u64 s[70:71], 0
    s_cbranch_scc1 L_CS1
    buffer_load_dword v18, v2, s[28:31], s83 offen offset:1024 sc1
L_CS1:
    s_cmp_eq_u64 s[72:73], 0
    s_cbranch_scc1 L_CS2
    buffer_load_dword v20, v2, s[28:31], s83 offen offset:2048 sc1
L_CS2:
    s_cmp_eq_u64 s[74:75], 0
    s_cbranch_scc1 L_CS3
    buffer_load_dword v22, v2, s[28:31], s83 offen offset:3072 sc1
L_CS3:
    s_cmp_eq_u64 s[76:77], 0
    s_cbranch_scc1 L_CS4
    buffer_load_dword v24, v2, s[28:31], s84 offen offset:0 sc1
L_CS4:
    s_cmp_eq_u64 s[78:79], 0
    s_cbranch_scc1 L_CS5
    buffer_load_dword v26, v2, s[28:31], s84 offen offset:1024 sc1
L_CS5:
    s_cmp_eq_u64 s[8:9], 0
    s_cbranch_scc1 L_CS6
    buffer_load_dword v28, v2, s[28:31], s84 offen offset:2048 sc1
L_CS6:
    s_cmp_eq_u64 s[10:11], 0
    s_cbranch_scc1 L_CS7
    buffer_load_dword v30, v2, s[28:31], s84 offen offset:3072 sc1
L_CS7:
    s_branch L_CG
L_CTO:
    s_mov_b32 s58, 0
    s_branch L_COK
L_EPO:
    v_mov_b32 v24, s55
    s_mov_b64 exec, 1
    buffer_store_dword v24, off, s[28:31], 0
    s_mov_b64 exec, -1
    s_branch L_EPOR
L_BPUB_SC1:
    buffer_store_dword v42, v15, s[28:31], s81 offen sc1
    v_fmac_f32 v17, v22, v23
    v_fmac_f32 v17, v24, v25
    v_fmac_f32 v17, v26, v27
    s_mov_b64 exec, 1
    buffer_store_dwordx2 v[16:17], off, s[28:31], s68 sc1
    s_branch L_BPUB_R
L_APUB_SC1:
    buffer_store_dword v26, v28, s[28:31], s87 offen sc1
    s_branch L_APUB_R
L_FB:
    s_load_dword s54, s[46:47], 0
    s_mov_b32 s73, 0
    v_lshlrev_b32 v32, 16, v28
    v_and_b32 v33, 0xffff0000, v28
    v_lshlrev_b32 v34, 16, v29
    v_and_b32 v35, 0xffff0000, v29
    v_lshlrev_b32 v36, 16, v30
    v_and_b32 v37, 0xffff0000, v30
    v_lshlrev_b32 v38, 16, v31
    v_and_b32 v39, 0xffff0000, v31
    v_lshlrev_b32 v24, 3, v1
    v_add_u32 v24, 136192, v24
    s_waitcnt lgkmcnt(0)
    s_lshl_b32 s54, s54, 16
L_FB_E:
    v_bfe_u32 v25, v32, 16, 15
    v_subrev_u32 v25, 14080, v25
    v_cmp_le_u32 vcc, s70, v25
    s_nop 0
    s_mov_b64 s[52:53], vcc
L_FB_L:
    s_cmp_eq_u64 s[52:53], 0
    s_cbranch_scc1 L_FB_N
    s_ff1_i32_b64 s74, s[52:53]
    s_bitset0_b64 s[52:53], s74
    s_nop 3
    v_readlane_b32 s75, v32, s74
    v_mov_b32 v26, 0
    v_mov_b32_e64 v27, v24
    s_mov_b32 s76, 0
L_FB_C:
    ds_read_b64 v[50:51], v27
    ds_read_b64 v[52:53], v27 offset:4096
    ds_read_b64 v[54:55], v27 offset:8192
    v_add_u32 v27, 512, v27
    s_waitcnt lgkmcnt(0)
    v_lshlrev_b32 v56, 16, v50
    v_lshlrev_b32 v57, 16, v52
    v_lshlrev_b32 v58, 16, v54
    v_fma_f32 v56, v56, s75, v57
    v_mul_f32 v57, v56, v56
    v_mov_b32 v59, 3222493025
    v_fmac_f32 v59, 3184710632, v57
    v_mul_f32 v57, v56, v59
    v_exp_f32 v57, v57
    v_mul_f32 v56, v56, v58
    v_add_f32 v57, 1.0, v57
    v_rcp_f32 v57, v57
    s_nop 0
    v_fmac_f32 v26, v56, v57
    v_and_b32 v56, 0xffff0000, v50
    v_and_b32 v57, 0xffff0000, v52
    v_and_b32 v58, 0xffff0000, v54
    v_fma_f32 v56, v56, s75, v57
    v_mul_f32 v57, v56, v56
    v_mov_b32 v59, 3222493025
    v_fmac_f32 v59, 3184710632, v57
    v_mul_f32 v57, v56, v59
    v_exp_f32 v57, v57
    v_mul_f32 v56, v56, v58
    v_add_f32 v57, 1.0, v57
    v_rcp_f32 v57, v57
    s_nop 0
    v_fmac_f32 v26, v56, v57
    v_lshlrev_b32 v56, 16, v51
    v_lshlrev_b32 v57, 16, v53
    v_lshlrev_b32 v58, 16, v55
    v_fma_f32 v56, v56, s75, v57
    v_mul_f32 v57, v56, v56
    v_mov_b32 v59, 3222493025
    v_fmac_f32 v59, 3184710632, v57
    v_mul_f32 v57, v56, v59
    v_exp_f32 v57, v57
    v_mul_f32 v56, v56, v58
    v_add_f32 v57, 1.0, v57
    v_rcp_f32 v57, v57
    s_nop 0
    v_fmac_f32_e64 v26, v56, v57
    v_and_b32 v56, 0xffff0000, v51
    v_and_b32 v57, 0xffff0000, v53
    v_and_b32 v58, 0xffff0000, v55
    v_fma_f32 v56, v56, s75, v57
    v_mul_f32 v57, v56, v56
    v_mov_b32 v59, 3222493025
    v_fmac_f32 v59, 3184710632, v57
    v_mul_f32 v57, v56, v59
    v_exp_f32 v57, v57
    v_mul_f32 v56, v56, v58
    v_add_f32 v57, 1.0, v57
    v_rcp_f32 v57, v57
    s_nop 0
    v_fmac_f32 v26, v56, v57
    s_add_u32 s76, s76, 512
    s_cmp_lt_u32 s76, 3584
    s_cbranch_scc1 L_FB_C
    v_add_f32_dpp v26, v26, v26 row_shr:1 row_mask:0xf bank_mask:0xf
    s_nop 1
    v_add_f32_dpp v26, v26, v26 row_shr:2 row_mask:0xf bank_mask:0xf
    s_nop 1
    v_add_f32_dpp v26, v26, v26 row_shr:4 row_mask:0xf bank_mask:0xf
    s_nop 1
    v_add_f32_dpp v26, v26, v26 row_shr:8 row_mask:0xf bank_mask:0xf
    s_nop 1
    v_add_f32_dpp v26, v26, v26 row_bcast:15 row_mask:0xa bank_mask:0xf
    s_nop 1
    v_add_f32_dpp v26, v26, v26 row_bcast:31 row_mask:0xc bank_mask:0xf
    v_add_f32 v26, s54, v26
    v_cvt_pk_bf16_f32 v26, v26, v26
    v_and_b32 v26, 0xffff0000, v26
    s_nop 0
    v_readlane_b32 s75, v26, 63
    s_mov_b32 m0, s74
    s_nop 3
    v_writelane_b32 v42, s75, m0
    s_branch L_FB_L
L_FB_N:
    v_mov_b32 v25, v32
    v_mov_b32 v26, v42
    v_mov_b32 v32, v33
    v_mov_b32 v42, v43
    v_mov_b32 v33, v34
    v_mov_b32 v43, v44
    v_mov_b32 v34, v35
    v_mov_b32 v44, v45
    v_mov_b32 v35, v36
    v_mov_b32 v45, v46
    v_mov_b32 v36, v37
    v_mov_b32 v46, v47
    v_mov_b32 v37, v38
    v_mov_b32 v47, v48
    v_mov_b32 v38, v39
    v_mov_b32 v48, v49
    v_mov_b32 v39, v25
    v_mov_b32 v49, v26
    s_add_u32 s73, s73, 1
    s_cmp_lt_u32 s73, 8
    s_cbranch_scc1 L_FB_E
    s_branch L_FBR
    s_nop 0
L_HELP2:
    v_mov_b32 v40, 128512
    s_mov_b32 s30, 268435456
    s_mov_b32 s31, 0x20000
    s_mov_b32 s58, 0x200000
    v_lshlrev_b32 v2, 2, v1
    v_lshlrev_b32 v29, 3, v1
    v_mov_b32 v22, 1
    s_barrier
    s_waitcnt vmcnt(0)
    s_mov_b64 exec, 1
    ds_add_u32 v40, v22 offset:28
    s_mov_b64 exec, -1
L_TAB:
L_sp15:
    ds_read_b32 v16, v40 offset:28
    s_waitcnt lgkmcnt(0)
    v_readfirstlane_b32 s68, v16
    s_nop 0
    s_cmp_ge_u32 s68, 4
    s_cbranch_scc1 L_spd16
    s_sub_u32 s58, s58, 1
    s_cbranch_scc0 L_sp15
    s_mov_b32 s58, 0
L_spd16:
    v_add_u32 v16, 136192, v28
    v_add_u32 v17, 136192, v29
    ds_read_b128 v[100:103], v16 offset:0
    ds_read_b128 v[104:107], v16 offset:1024
    ds_read_b128 v[108:111], v16 offset:2048
    ds_read_b64 v[112:113], v17 offset:3072
    ds_read_b128 v[114:117], v16 offset:4096
    ds_read_b128 v[118:121], v16 offset:5120
    ds_read_b128 v[122:125], v16 offset:6144
    ds_read_b64 v[126:127], v17 offset:7168
    ds_read_b128 v[128:131], v16 offset:8192
    ds_read_b128 v[132:135], v16 offset:9216
    ds_read_b128 v[136:139], v16 offset:10240
    ds_read_b64 v[140:141], v17 offset:11264
    s_sub_u32 s68, s3, 4
    s_lshl_b32 s68, s68, 3
    s_lshr_b32 s69, 252314880, s68
    s_and_b32 s69, s69, 0xff
    s_lshr_b32 s70, 84215045, s68
    s_and_b32 s70, s70, 0xff
    s_mul_i32 s71, s2, 10
    s_mov_b32 s72, 0
    s_setprio 0
    s_waitcnt lgkmcnt(0)
    s_lshl_b32 s54, s54, 16
    v_lshlrev_b32 v144, 16, v100
    v_and_b32 v145, 0xffff0000, v100
    v_lshlrev_b32 v172, 16, v114
    v_and_b32 v173, 0xffff0000, v114
    v_lshlrev_b32 v200, 16, v128
    v_and_b32 v201, 0xffff0000, v128
    v_lshlrev_b32 v146, 16, v101
    v_and_b32 v147, 0xffff0000, v101
    v_lshlrev_b32 v174, 16, v115
    v_and_b32 v175, 0xffff0000, v115
    v_lshlrev_b32 v202, 16, v129
    v_and_b32 v203, 0xffff0000, v129
    v_lshlrev_b32 v148, 16, v102
    v_and_b32 v149, 0xffff0000, v102
    v_lshlrev_b32 v176, 16, v116
    v_and_b32 v177, 0xffff0000, v116
    v_lshlrev_b32 v204, 16, v130
    v_and_b32 v205, 0xffff0000, v130
    v_lshlrev_b32 v150, 16, v103
    v_and_b32 v151, 0xffff0000, v103
    v_lshlrev_b32 v178, 16, v117
    v_and_b32 v179, 0xffff0000, v117
    v_lshlrev_b32 v206, 16, v131
    v_and_b32 v207, 0xffff0000, v131
    v_lshlrev_b32 v152, 16, v104
    v_and_b32 v153, 0xffff0000, v104
    v_lshlrev_b32 v180, 16, v118
    v_and_b32 v181, 0xffff0000, v118
    v_lshlrev_b32 v208, 16, v132
    v_and_b32 v209, 0xffff0000, v132
    v_lshlrev_b32 v154, 16, v105
    v_and_b32 v155, 0xffff0000, v105
    v_lshlrev_b32 v182, 16, v119
    v_and_b32 v183, 0xffff0000, v119
    v_lshlrev_b32 v210, 16, v133
    v_and_b32 v211, 0xffff0000, v133
    v_lshlrev_b32 v156, 16, v106
    v_and_b32 v157, 0xffff0000, v106
    v_lshlrev_b32 v184, 16, v120
    v_and_b32 v185, 0xffff0000, v120
    v_lshlrev_b32 v212, 16, v134
    v_and_b32 v213, 0xffff0000, v134
    v_lshlrev_b32 v158, 16, v107
    v_and_b32 v159, 0xffff0000, v107
    v_lshlrev_b32 v186, 16, v121
    v_and_b32 v187, 0xffff0000, v121
    v_lshlrev_b32 v214, 16, v135
    v_and_b32 v215, 0xffff0000, v135
    v_lshlrev_b32 v160, 16, v108
    v_and_b32 v161, 0xffff0000, v108
    v_lshlrev_b32 v188, 16, v122
    v_and_b32 v189, 0xffff0000, v122
    v_lshlrev_b32 v216, 16, v136
    v_and_b32 v217, 0xffff0000, v136
    v_lshlrev_b32 v162, 16, v109
    v_and_b32 v163, 0xffff0000, v109
    v_lshlrev_b32 v190, 16, v123
    v_and_b32 v191, 0xffff0000, v123
    v_lshlrev_b32 v218, 16, v137
    v_and_b32 v219, 0xffff0000, v137
    v_lshlrev_b32 v164, 16, v110
    v_and_b32 v165, 0xffff0000, v110
    v_lshlrev_b32 v192, 16, v124
    v_and_b32 v193, 0xffff0000, v124
    v_lshlrev_b32 v220, 16, v138
    v_and_b32 v221, 0xffff0000, v138
    v_lshlrev_b32 v166, 16, v111
    v_and_b32 v167, 0xffff0000, v111
    v_lshlrev_b32 v194, 16, v125
    v_and_b32 v195, 0xffff0000, v125
    v_lshlrev_b32 v222, 16, v139
    v_and_b32 v223, 0xffff0000, v139
    v_lshlrev_b32 v168, 16, v112
    v_and_b32 v169, 0xffff0000, v112
    v_lshlrev_b32 v196, 16, v126
    v_and_b32 v197, 0xffff0000, v126
    v_lshlrev_b32 v224, 16, v140
    v_and_b32 v225, 0xffff0000, v140
    v_lshlrev_b32 v170, 16, v113
    v_and_b32 v171, 0xffff0000, v113
    v_lshlrev_b32 v198, 16, v127
    v_and_b32 v199, 0xffff0000, v127
    v_lshlrev_b32 v226, 16, v141
    v_and_b32 v227, 0xffff0000, v141
    v_mov_b32 v16, 3222493025
    v_mov_b32 v17, 3222493025
    v_mov_b32 v18, 3184710632
    v_mov_b32 v19, 3184710632
L_TABE:
    s_add_u32 s73, s69, s72
    s_cmp_ge_u32 s73, 10
    s_cselect_b32 s74, 32758, 0
    s_add_u32 s73, s73, s74
    s_add_u32 s73, s73, s71
    s_add_u32 s73, s73, 14080
    s_lshl_b32 s73, s73, 16
    v_mov_b32 v20, s73
    v_mov_b32 v21, s73
.p2align 3
    v_pk_fma_f32 v[32:33], v[144:145], v[20:21], v[172:173]
    v_pk_fma_f32 v[34:35], v[146:147], v[20:21], v[174:175]
    v_pk_mul_f32 v[36:37], v[32:33], v[32:33]
    v_pk_mul_f32 v[38:39], v[34:35], v[34:35]
    v_pk_fma_f32 v[36:37], v[36:37], v[18:19], v[16:17]
    v_pk_fma_f32 v[38:39], v[38:39], v[18:19], v[16:17]
    v_pk_mul_f32 v[36:37], v[32:33], v[36:37]
    v_pk_mul_f32 v[38:39], v[34:35], v[38:39]
    v_exp_f32 v36, v36
    v_exp_f32 v37, v37
    v_exp_f32 v38, v38
    v_exp_f32 v39, v39
    v_pk_mul_f32 v[42:43], v[32:33], v[200:201]
    v_pk_mul_f32 v[44:45], v[34:35], v[202:203]
    v_pk_add_f32 v[36:37], v[36:37], 1.0 op_sel_hi:[1,0]
    v_pk_add_f32 v[38:39], v[38:39], 1.0 op_sel_hi:[1,0]
    v_rcp_f32 v38, v38
    v_rcp_f32 v39, v39
    v_rcp_f32 v36, v36
    v_rcp_f32 v37, v37
    v_pk_mul_f32 v[26:27], v[44:45], v[38:39]
    v_pk_mul_f32 v[24:25], v[42:43], v[36:37]
    v_pk_fma_f32 v[32:33], v[148:149], v[20:21], v[176:177]
    v_pk_fma_f32 v[34:35], v[150:151], v[20:21], v[178:179]
    v_pk_mul_f32 v[36:37], v[32:33], v[32:33]
    v_pk_mul_f32 v[38:39], v[34:35], v[34:35]
    v_pk_fma_f32 v[36:37], v[36:37], v[18:19], v[16:17]
    v_pk_fma_f32 v[38:39], v[38:39], v[18:19], v[16:17]
    v_pk_mul_f32 v[36:37], v[32:33], v[36:37]
    v_pk_mul_f32 v[38:39], v[34:35], v[38:39]
    v_exp_f32 v36, v36
    v_exp_f32 v37, v37
    v_exp_f32 v38, v38
    v_exp_f32 v39, v39
    v_pk_mul_f32 v[42:43], v[32:33], v[204:205]
    v_pk_mul_f32 v[44:45], v[34:35], v[206:207]
    v_pk_add_f32 v[36:37], v[36:37], 1.0 op_sel_hi:[1,0]
    v_pk_add_f32 v[38:39], v[38:39], 1.0 op_sel_hi:[1,0]
    v_rcp_f32 v38, v38
    v_rcp_f32 v39, v39
    v_rcp_f32 v36, v36
    v_rcp_f32 v37, v37
    v_pk_fma_f32 v[26:27], v[44:45], v[38:39], v[26:27]
    v_pk_fma_f32 v[24:25], v[42:43], v[36:37], v[24:25]
    v_pk_fma_f32 v[32:33], v[152:153], v[20:21], v[180:181]
    v_pk_fma_f32 v[34:35], v[154:155], v[20:21], v[182:183]
    v_pk_mul_f32 v[36:37], v[32:33], v[32:33]
    v_pk_mul_f32 v[38:39], v[34:35], v[34:35]
    v_pk_fma_f32 v[36:37], v[36:37], v[18:19], v[16:17]
    v_pk_fma_f32 v[38:39], v[38:39], v[18:19], v[16:17]
    v_pk_mul_f32 v[36:37], v[32:33], v[36:37]
    v_pk_mul_f32 v[38:39], v[34:35], v[38:39]
    v_exp_f32 v36, v36
    v_exp_f32 v37, v37
    v_exp_f32 v38, v38
    v_exp_f32 v39, v39
    v_pk_mul_f32 v[42:43], v[32:33], v[208:209]
    v_pk_mul_f32 v[44:45], v[34:35], v[210:211]
    v_pk_add_f32 v[36:37], v[36:37], 1.0 op_sel_hi:[1,0]
    v_pk_add_f32 v[38:39], v[38:39], 1.0 op_sel_hi:[1,0]
    v_rcp_f32 v38, v38
    v_rcp_f32 v39, v39
    v_rcp_f32 v36, v36
    v_rcp_f32 v37, v37
    v_pk_fma_f32 v[26:27], v[44:45], v[38:39], v[26:27]
    v_pk_fma_f32 v[24:25], v[42:43], v[36:37], v[24:25]
    v_pk_fma_f32 v[32:33], v[156:157], v[20:21], v[184:185]
    v_pk_fma_f32 v[34:35], v[158:159], v[20:21], v[186:187]
    v_pk_mul_f32 v[36:37], v[32:33], v[32:33]
    v_pk_mul_f32 v[38:39], v[34:35], v[34:35]
    v_pk_fma_f32 v[36:37], v[36:37], v[18:19], v[16:17]
    v_pk_fma_f32 v[38:39], v[38:39], v[18:19], v[16:17]
    v_pk_mul_f32 v[36:37], v[32:33], v[36:37]
    v_pk_mul_f32 v[38:39], v[34:35], v[38:39]
    v_exp_f32 v36, v36
    v_exp_f32 v37, v37
    v_exp_f32 v38, v38
    v_exp_f32 v39, v39
    v_pk_mul_f32 v[42:43], v[32:33], v[212:213]
    v_pk_mul_f32 v[44:45], v[34:35], v[214:215]
    v_pk_add_f32 v[36:37], v[36:37], 1.0 op_sel_hi:[1,0]
    v_pk_add_f32 v[38:39], v[38:39], 1.0 op_sel_hi:[1,0]
    v_rcp_f32 v38, v38
    v_rcp_f32 v39, v39
    v_rcp_f32 v36, v36
    v_rcp_f32 v37, v37
    v_pk_fma_f32 v[26:27], v[44:45], v[38:39], v[26:27]
    v_pk_fma_f32 v[24:25], v[42:43], v[36:37], v[24:25]
    v_pk_fma_f32 v[32:33], v[160:161], v[20:21], v[188:189]
    v_pk_fma_f32 v[34:35], v[162:163], v[20:21], v[190:191]
    v_pk_mul_f32 v[36:37], v[32:33], v[32:33]
    v_pk_mul_f32 v[38:39], v[34:35], v[34:35]
    v_pk_fma_f32 v[36:37], v[36:37], v[18:19], v[16:17]
    v_pk_fma_f32 v[38:39], v[38:39], v[18:19], v[16:17]
    v_pk_mul_f32 v[36:37], v[32:33], v[36:37]
    v_pk_mul_f32 v[38:39], v[34:35], v[38:39]
    v_exp_f32 v36, v36
    v_exp_f32 v37, v37
    v_exp_f32 v38, v38
    v_exp_f32 v39, v39
    v_pk_mul_f32 v[42:43], v[32:33], v[216:217]
    v_pk_mul_f32 v[44:45], v[34:35], v[218:219]
    v_pk_add_f32 v[36:37], v[36:37], 1.0 op_sel_hi:[1,0]
    v_pk_add_f32 v[38:39], v[38:39], 1.0 op_sel_hi:[1,0]
    v_rcp_f32 v38, v38
    v_rcp_f32 v39, v39
    v_rcp_f32 v36, v36
    v_rcp_f32 v37, v37
    v_pk_fma_f32 v[26:27], v[44:45], v[38:39], v[26:27]
    v_pk_fma_f32 v[24:25], v[42:43], v[36:37], v[24:25]
    v_pk_fma_f32 v[32:33], v[164:165], v[20:21], v[192:193]
    v_pk_fma_f32 v[34:35], v[166:167], v[20:21], v[194:195]
    v_pk_mul_f32 v[36:37], v[32:33], v[32:33]
    v_pk_mul_f32 v[38:39], v[34:35], v[34:35]
    v_pk_fma_f32 v[36:37], v[36:37], v[18:19], v[16:17]
    v_pk_fma_f32 v[38:39], v[38:39], v[18:19], v[16:17]
    v_pk_mul_f32 v[36:37], v[32:33], v[36:37]
    v_pk_mul_f32 v[38:39], v[34:35], v[38:39]
    v_exp_f32 v36, v36
    v_exp_f32 v37, v37
    v_exp_f32 v38, v38
    v_exp_f32 v39, v39
    v_pk_mul_f32 v[42:43], v[32:33], v[220:221]
    v_pk_mul_f32 v[44:45], v[34:35], v[222:223]
    v_pk_add_f32 v[36:37], v[36:37], 1.0 op_sel_hi:[1,0]
    v_pk_add_f32 v[38:39], v[38:39], 1.0 op_sel_hi:[1,0]
    v_rcp_f32 v38, v38
    v_rcp_f32 v39, v39
    v_rcp_f32 v36, v36
    v_rcp_f32 v37, v37
    v_pk_fma_f32 v[26:27], v[44:45], v[38:39], v[26:27]
    v_pk_fma_f32 v[24:25], v[42:43], v[36:37], v[24:25]
    v_pk_fma_f32 v[32:33], v[168:169], v[20:21], v[196:197]
    v_pk_fma_f32 v[34:35], v[170:171], v[20:21], v[198:199]
    v_pk_mul_f32 v[36:37], v[32:33], v[32:33]
    v_pk_mul_f32 v[38:39], v[34:35], v[34:35]
    v_pk_fma_f32 v[36:37], v[36:37], v[18:19], v[16:17]
    v_pk_fma_f32 v[38:39], v[38:39], v[18:19], v[16:17]
    v_pk_mul_f32 v[36:37], v[32:33], v[36:37]
    v_pk_mul_f32 v[38:39], v[34:35], v[38:39]
    v_exp_f32 v36, v36
    v_exp_f32 v37, v37
    v_exp_f32 v38, v38
    v_exp_f32 v39, v39
    v_pk_mul_f32 v[42:43], v[32:33], v[224:225]
    v_pk_mul_f32 v[44:45], v[34:35], v[226:227]
    v_pk_add_f32 v[36:37], v[36:37], 1.0 op_sel_hi:[1,0]
    v_pk_add_f32 v[38:39], v[38:39], 1.0 op_sel_hi:[1,0]
    v_rcp_f32 v38, v38
    v_rcp_f32 v39, v39
    v_rcp_f32 v36, v36
    v_rcp_f32 v37, v37
    v_pk_fma_f32 v[26:27], v[44:45], v[38:39], v[26:27]
    v_pk_fma_f32 v[24:25], v[42:43], v[36:37], v[24:25]
    v_pk_add_f32 v[24:25], v[24:25], v[26:27]
    v_mov_b32 v92, v93
    v_mov_b32 v93, v94
    v_mov_b32 v94, v95
    v_mov_b32 v95, v96
    v_add_f32 v96, v24, v25
    s_add_u32 s72, s72, 1
    s_cmp_lt_u32 s72, s70
    s_cbranch_scc1 L_TABE
    v_add_f32_dpp v92, v92, v92 row_shr:1 row_mask:0xf bank_mask:0xf
    v_add_f32_dpp v93, v93, v93 row_shr:1 row_mask:0xf bank_mask:0xf
    v_add_f32_dpp v94, v94, v94 row_shr:1 row_mask:0xf bank_mask:0xf
    v_add_f32_dpp v95, v95, v95 row_shr:1 row_mask:0xf bank_mask:0xf
    v_add_f32_dpp v96, v96, v96 row_shr:1 row_mask:0xf bank_mask:0xf
    v_add_f32_dpp v92, v92, v92 row_shr:2 row_mask:0xf bank_mask:0xf
    v_add_f32_dpp v93, v93, v93 row_shr:2 row_mask:0xf bank_mask:0xf
    v_add_f32_dpp v94, v94, v94 row_shr:2 row_mask:0xf bank_mask:0xf
    v_add_f32_dpp v95, v95, v95 row_shr:2 row_mask:0xf bank_mask:0xf
    v_add_f32_dpp v96, v96, v96 row_shr:2 row_mask:0xf bank_mask:0xf
    v_add_f32_dpp v92, v92, v92 row_shr:4 row_mask:0xf bank_mask:0xf
    v_add_f32_dpp v93, v93, v93 row_shr:4 row_mask:0xf bank_mask:0xf
    v_add_f32_dpp v94, v94, v94 row_shr:4 row_mask:0xf bank_mask:0xf
    v_add_f32_dpp v95, v95, v95 row_shr:4 row_mask:0xf bank_mask:0xf
    v_add_f32_dpp v96, v96, v96 row_shr:4 row_mask:0xf bank_mask:0xf
    v_add_f32_dpp v92, v92, v92 row_shr:8 row_mask:0xf bank_mask:0xf
    v_add_f32_dpp v93, v93, v93 row_shr:8 row_mask:0xf bank_mask:0xf
    v_add_f32_dpp v94, v94, v94 row_shr:8 row_mask:0xf bank_mask:0xf
    v_add_f32_dpp v95, v95, v95 row_shr:8 row_mask:0xf bank_mask:0xf
    v_add_f32_dpp v96, v96, v96 row_shr:8 row_mask:0xf bank_mask:0xf
    v_add_f32_dpp v92, v92, v92 row_bcast:15 row_mask:0xa bank_mask:0xf
    v_add_f32_dpp v93, v93, v93 row_bcast:15 row_mask:0xa bank_mask:0xf
    v_add_f32_dpp v94, v94, v94 row_bcast:15 row_mask:0xa bank_mask:0xf
    v_add_f32_dpp v95, v95, v95 row_bcast:15 row_mask:0xa bank_mask:0xf
    v_add_f32_dpp v96, v96, v96 row_bcast:15 row_mask:0xa bank_mask:0xf
    v_add_f32_dpp v92, v92, v92 row_bcast:31 row_mask:0xc bank_mask:0xf
    v_add_f32_dpp v93, v93, v93 row_bcast:31 row_mask:0xc bank_mask:0xf
    v_add_f32_dpp v94, v94, v94 row_bcast:31 row_mask:0xc bank_mask:0xf
    v_add_f32_dpp v95, v95, v95 row_bcast:31 row_mask:0xc bank_mask:0xf
    v_add_f32_dpp v96, v96, v96 row_bcast:31 row_mask:0xc bank_mask:0xf
    v_add_f32 v92, s54, v92
    v_add_f32 v93, s54, v93
    v_add_f32 v94, s54, v94
    v_add_f32 v95, s54, v95
    v_add_f32 v96, s54, v96
L_sp17:
    ds_read_b32 v21, v40 offset:0
    s_waitcnt lgkmcnt(0)
    v_readfirstlane_b32 s55, v21
    s_nop 0
    s_cmp_ge_u32 s55, 1
    s_cbranch_scc1 L_spd18
    s_sub_u32 s58, s58, 1
    s_cbranch_scc0 L_sp17
    s_mov_b32 s58, 0
L_spd18:
    s_lshl_b32 s69, s69, 2
    s_add_u32 s69, s69, 128576
    v_mov_b32 v16, s69
    s_mov_b32 exec_lo, 0
    s_mov_b32 exec_hi, 0x80000000
    ds_write_b32 v16, v92 offset:0
    ds_write_b32 v16, v93 offset:4
    ds_write_b32 v16, v94 offset:8
    ds_write_b32 v16, v95 offset:12
    ds_write_b32 v16, v96 offset:16
    s_mov_b64 exec, 1
    ds_add_rtn_u32 v18, v40, v22 offset:24
    s_mov_b64 exec, -1
    s_waitcnt lgkmcnt(0)
    v_readfirstlane_b32 s68, v18
    s_nop 0
    s_cmp_lg_u32 s68, 3
    s_cbranch_scc1 L_TABW
    v_add_u32 v16, 128576, v29
    ds_read_b64 v[18:19], v16
    s_lshl_b32 s68, s2, 7
    s_add_u32 s68, s68, 1282048
    s_waitcnt lgkmcnt(0)
    v_cvt_pk_bf16_f32 v20, v18, v19
    s_mov_b64 exec, 1023
    buffer_store_dwordx2 v[20:21], v29, s[28:31], s68 offen sc1
    s_mov_b64 exec, -1
L_TABW:
    s_sub_u32 s68, s3, 4
    s_lshl_b32 s69, s68, 13
    s_add_u32 s69, s69, 1282048
    s_add_u32 s70, s69, 4096
    s_mul_i32 s68, s68, 1280
    s_add_u32 s68, s68, 65536
    v_lshrrev_b32 v16, 3, v1
    v_mul_u32_u24 v16, 20, v16
    v_and_b32 v17, 7, v1
    v_lshl_add_u32 v16, v17, 3, v16
    v_add_u32 v16, s68, v16
    v_lshlrev_b32 v17, 1, v17
    v_add_u32 v18, 65516, v16
    v_cmp_le_u32 vcc, 5, v17
    s_nop 1
    v_cndmask_b32 v19, v16, v18, vcc
    v_cmp_le_u32 vcc, 4, v17
    s_nop 1
    v_cndmask_b32 v18, v16, v18, vcc
    s_cmp_lg_u32 s3, 5
    s_cbranch_scc1 L_NPT
L_sp19:
    ds_read_b32 v20, v40 offset:4
    s_waitcnt lgkmcnt(0)
    v_readfirstlane_b32 s68, v20
    s_nop 0
    s_cmp_ge_u32 s68, 1
    s_cbranch_scc1 L_spd20
    s_nop 0
    s_sleep 2
    s_sub_u32 s58, s58, 1
    s_cbranch_scc0 L_sp19
    s_mov_b32 s58, 0
L_spd20:
    s_lshr_b32 s71, s2, 6
    s_lshl_b32 s71, s71, 3
    s_and_b32 s72, s2, 7
    s_add_u32 s71, s71, s72
    s_lshl_b32 s72, s71, 10
    s_add_u32 s72, s72, 528384
    s_mul_i32 s71, s71, 9216
    buffer_load_dwordx4 v[80:83], v28, s[28:31], s72 offen sc1
    s_add_u32 s72, s71, 856064
    buffer_load_dwordx4 v[80:83], v28, s[28:31], s72 offen offset:0 sc1
    buffer_load_dwordx4 v[80:83], v28, s[28:31], s72 offen offset:1024 sc1
    buffer_load_dwordx4 v[80:83], v28, s[28:31], s72 offen offset:2048 sc1
    buffer_load_dwordx4 v[80:83], v28, s[28:31], s72 offen offset:3072 sc1
    s_add_u32 s72, s71, 860160
    buffer_load_dwordx4 v[80:83], v28, s[28:31], s72 offen offset:0 sc1
    buffer_load_dwordx4 v[80:83], v28, s[28:31], s72 offen offset:1024 sc1
    buffer_load_dwordx4 v[80:83], v28, s[28:31], s72 offen offset:2048 sc1
    buffer_load_dwordx4 v[80:83], v28, s[28:31], s72 offen offset:3072 sc1
    s_add_u32 s72, s71, 864256
    buffer_load_dwordx4 v[80:83], v28, s[28:31], s72 offen offset:0 sc1
L_NPT:
    v_lshrrev_b32 v90, 3, v1
    v_and_b32 v23, 7, v1
    v_bfe_u32 v91, v1, 4, 1
    v_lshlrev_b32 v91, 1, v91
    v_xor_b32 v23, v23, v91
    v_lshlrev_b32 v23, 4, v23
    v_lshl_add_u32 v90, v90, 13, v23
    v_xor_b32 v91, 64, v90
    s_mov_b32 s22, 0x400000
    s_mov_b32 s23, 0x20000
    s_and_b32 s80, s2, 7
    s_lshl_b32 s80, s80, 3
    s_bfe_u32 s81, s2, 0x30003
    s_add_u32 s80, s80, s81
    s_lshl_b32 s80, s80, 7
    s_and_b32 s81, s3, 3
    s_mul_i32 s82, s81, 3
    s_lshr_b32 s83, s2, 6
    s_lshl_b32 s83, s83, 2
    s_add_u32 s82, s82, s83
    s_lshl_b32 s81, s81, 13
L_sp21:
    ds_read_b32 v31, v40 offset:8
    s_waitcnt lgkmcnt(0)
    v_readfirstlane_b32 s83, v31
    s_nop 0
    s_cmp_ge_u32 s83, 4
    s_cbranch_scc1 L_spd22
    s_sleep 1
    s_sub_u32 s58, s58, 1
    s_cbranch_scc0 L_sp21
    s_mov_b32 s58, 0
L_spd22:
    s_add_u32 s83, s82, 4
    s_and_b32 s83, s83, 15
    s_lshl_b32 s83, s83, 18
    s_add_u32 s83, s83, s80
    s_add_u32 s84, s81, 0
    s_mov_b32 m0, s84
    s_nop 0
    buffer_load_dwordx4 v90, s[20:23], s83 offen offset:0 lds
    s_add_u32 s83, s83, 64512
    buffer_load_dwordx4 v91, s[20:23], s83 offen offset:1024 lds
    s_add_u32 s83, s83, 64512
    buffer_load_dwordx4 v90, s[20:23], s83 offen offset:2048 lds
    s_add_u32 s83, s83, 64512
    buffer_load_dwordx4 v91, s[20:23], s83 offen offset:3072 lds
    s_add_u32 s83, s82, 5
    s_and_b32 s83, s83, 15
    s_lshl_b32 s83, s83, 18
    s_add_u32 s83, s83, s80
    s_add_u32 s84, s81, 4096
    s_mov_b32 m0, s84
    s_nop 0
    buffer_load_dwordx4 v90, s[20:23], s83 offen offset:0 lds
    s_add_u32 s83, s83, 64512
    buffer_load_dwordx4 v91, s[20:23], s83 offen offset:1024 lds
    s_add_u32 s83, s83, 64512
    buffer_load_dwordx4 v90, s[20:23], s83 offen offset:2048 lds
    s_add_u32 s83, s83, 64512
    buffer_load_dwordx4 v91, s[20:23], s83 offen offset:3072 lds
    s_add_u32 s83, s82, 6
    s_and_b32 s83, s83, 15
    s_lshl_b32 s83, s83, 18
    s_add_u32 s83, s83, s80
    s_add_u32 s84, s81, 74752
    s_mov_b32 m0, s84
    s_nop 0
    buffer_load_dwordx4 v90, s[20:23], s83 offen offset:0 lds
    s_add_u32 s83, s83, 64512
    buffer_load_dwordx4 v91, s[20:23], s83 offen offset:1024 lds
    s_add_u32 s83, s83, 64512
    buffer_load_dwordx4 v90, s[20:23], s83 offen offset:2048 lds
    s_add_u32 s83, s83, 64512
    buffer_load_dwordx4 v91, s[20:23], s83 offen offset:3072 lds
    s_waitcnt vmcnt(0)
L_sp23:
    ds_read_b32 v20, v40 offset:32
    s_waitcnt lgkmcnt(0)
    v_readfirstlane_b32 s68, v20
    s_nop 0
    s_cmp_ge_u32 s68, 1
    s_cbranch_scc1 L_spd24
    s_sleep 2
    s_sub_u32 s58, s58, 1
    s_cbranch_scc0 L_sp23
    s_mov_b32 s58, 0
L_spd24:
    s_mov_b32 s68, 522133279
    s_mov_b32 exec_lo, s68
    s_mov_b32 exec_hi, s68
    buffer_load_dwordx4 v[48:51], v28, s[28:31], s69 offen offset:0 sc1
    buffer_load_dwordx4 v[52:55], v28, s[28:31], s69 offen offset:1024 sc1
    buffer_load_dwordx4 v[56:59], v28, s[28:31], s69 offen offset:2048 sc1
    buffer_load_dwordx4 v[60:63], v28, s[28:31], s69 offen offset:3072 sc1
    buffer_load_dwordx4 v[64:67], v28, s[28:31], s70 offen offset:0 sc1
    buffer_load_dwordx4 v[68:71], v28, s[28:31], s70 offen offset:1024 sc1
    buffer_load_dwordx4 v[72:75], v28, s[28:31], s70 offen offset:2048 sc1
    buffer_load_dwordx4 v[76:79], v28, s[28:31], s70 offen offset:3072 sc1
    s_mov_b64 exec, -1
    s_barrier
    s_cmp_lg_u32 s3, 5
    s_cbranch_scc1 L_NRG
    s_lshr_b32 s71, s2, 6
    s_lshl_b32 s71, s71, 12
    s_add_u32 s71, s71, 1331200
    v_lshlrev_b32 v20, 6, v1
L_RG:
    buffer_load_dwordx2 v[84:85], v20, s[28:31], s71 offen sc1
    s_waitcnt vmcnt(0)
    v_cmp_ne_u32 vcc, s55, v85
    s_cbranch_vccz L_RGOK
    s_mov_b64 exec, vcc
    s_sleep 4
    s_sub_u32 s58, s58, 1
    s_cbranch_scc0 L_RG
    s_mov_b32 s58, 0
L_RGOK:
    s_mov_b64 exec, -1
    ds_write_b32 v40, v22 offset:44
L_NRG:
    s_mov_b32 exec_lo, s68
    s_mov_b32 exec_hi, s68
    s_branch L_TGW
    s_nop 0
L_TG:
    buffer_load_dwordx4 v[48:51], v28, s[28:31], s69 offen offset:0 sc1
    buffer_load_dwordx4 v[52:55], v28, s[28:31], s69 offen offset:1024 sc1
    buffer_load_dwordx4 v[56:59], v28, s[28:31], s69 offen offset:2048 sc1
    buffer_load_dwordx4 v[60:63], v28, s[28:31], s69 offen offset:3072 sc1
    buffer_load_dwordx4 v[64:67], v28, s[28:31], s70 offen offset:0 sc1
    buffer_load_dwordx4 v[68:71], v28, s[28:31], s70 offen offset:1024 sc1
    buffer_load_dwordx4 v[72:75], v28, s[28:31], s70 offen offset:2048 sc1
    buffer_load_dwordx4 v[76:79], v28, s[28:31], s70 offen offset:3072 sc1
L_TGW:
    s_nop 0
    s_waitcnt vmcnt(0)
    v_max3_u32 v20, v49, v51, v53
    v_min3_u32 v21, v49, v51, v53
    v_max3_u32 v20, v20, v55, v57
    v_min3_u32 v21, v21, v55, v57
    v_max3_u32 v20, v20, v59, v61
    v_min3_u32 v21, v21, v59, v61
    v_max3_u32 v20, v20, v63, v65
    v_min3_u32 v21, v21, v63, v65
    v_max3_u32 v20, v20, v67, v69
    v_min3_u32 v21, v21, v67, v69
    v_max3_u32 v20, v20, v71, v73
    v_min3_u32 v21, v21, v71, v73
    v_max3_u32 v20, v20, v75, v77
    v_min3_u32 v21, v21, v75, v77
    v_max_u32 v20, v20, v79
    v_min_u32 v21, v21, v79
    v_xor_b32 v20, s55, v20
    v_xor_b32 v21, s55, v21
    v_or_b32 v20, v20, v21
    v_cmp_ne_u32 vcc, 0, v20
    s_cbranch_vccz L_TGOK
    s_mov_b64 exec, vcc
    s_sleep 8
    s_sub_u32 s58, s58, 1
    s_cbranch_scc0 L_TG
    s_mov_b32 s58, 0
L_TGOK:
    s_mov_b32 exec_lo, s68
    s_mov_b32 exec_hi, s68
    ds_write_b32 v19, v48 offset:0
    ds_write_b32 v18, v50 offset:4
    ds_write_b32 v19, v52 offset:160
    ds_write_b32 v18, v54 offset:164
    ds_write_b32 v19, v56 offset:320
    ds_write_b32 v18, v58 offset:324
    ds_write_b32 v19, v60 offset:480
    ds_write_b32 v18, v62 offset:484
    ds_write_b32 v19, v64 offset:640
    ds_write_b32 v18, v66 offset:644
    ds_write_b32 v19, v68 offset:800
    ds_write_b32 v18, v70 offset:804
    ds_write_b32 v19, v72 offset:960
    ds_write_b32 v18, v74 offset:964
    ds_write_b32 v19, v76 offset:1120
    ds_write_b32 v18, v78 offset:1124
    s_mov_b64 exec, -1
    s_waitcnt lgkmcnt(0)
    s_branch L_FIN
L_CODE_END:
.fill (interleave_layers__sliding_block_cached__mixer_token_mlp__decode_kernel+17408-L_CODE_END)/4, 4, 0xbf800000
.section .rodata,"a"
.p2align 6
.amdhsa_kernel interleave_layers__sliding_block_cached__mixer_token_mlp__decode_kernel
.amdhsa_next_free_vgpr 256
.amdhsa_next_free_sgpr 102
.amdhsa_accum_offset 256
.amdhsa_group_segment_fixed_size 0
.amdhsa_kernarg_size 104
.amdhsa_user_sgpr_count 2
.amdhsa_user_sgpr_kernarg_segment_ptr 1
.amdhsa_system_sgpr_workgroup_id_x 1
.end_amdhsa_kernel
```
